```python
import torch

def _softmax(x, axis=-1):
    return torch.softmax(x, dim=axis)
def _gelu(x):
    return torch.nn.functional.gelu(x, approximate="tanh")
def _silu(x):
    return torch.nn.functional.silu(x)
def _sigmoid(x):
    return torch.sigmoid(x)
def _layernorm(x, axis=-1, eps=1e-5):
    m = x.mean(dim=axis, keepdim=True)
    v = x.var(dim=axis, keepdim=True, unbiased=False)
    return (x - m) / torch.sqrt(v + eps)
def _scatter_add(tgt, idx, src, axis=0):
    return tgt.clone().index_add_(axis, idx, src)
def _segment_sum(src, seg, n):
    out = torch.zeros((n,) + src.shape[1:], dtype=src.dtype)
    return out.index_add_(0, seg, src)
def _pad(x, pw):
    flat = tuple(v for pair in reversed(pw) for v in pair)
    return torch.nn.functional.pad(x, flat)

kernel_name = 'standalone__weight_only_int_quip__prompt'

def setup_inputs():

    _w = (lambda a: (lambda t: t.to(torch.bfloat16) if t.is_floating_point() else t)(torch.as_tensor(a)))
    B, S, D, F = 1, 2048, 640, 1536
    G = 128 if 128 > 0 else D
    D = (D // G) * G
    ng = D // G
    bits = 4 if 4 > 0 else 4
    qmax = 1 << bits
    qw = torch.randint(0, qmax, (D, F)).to(torch.int32)
    U, _ = (lambda *_a, **_k: torch.linalg.qr(*[torch.as_tensor(_x).float() for _x in _a], **_k))((lambda *s: torch.randn(*s, dtype=torch.bfloat16) * 0.05)(D, D))
    V, _ = (lambda *_a, **_k: torch.linalg.qr(*[torch.as_tensor(_x).float() for _x in _a], **_k))((lambda *s: torch.randn(*s, dtype=torch.bfloat16) * 0.05)(F, F))
    return {
        "x": _w((lambda *s: torch.randn(*s, dtype=torch.bfloat16) * 0.05)(B, S, D)),
        "qw": _w(qw),
        "scales": _w(torch.abs((lambda *s: torch.randn(*s, dtype=torch.bfloat16) * 0.05)(ng, F)) * 0.02 + 0.005),
        "zeros": _w(torch.full((ng, F), qmax / 2.0, dtype=float)),
        "U": _w(U.to(float)),
        "V": _w(V.to(float)),
    }

def reference(x, qw, scales, zeros, U, V):
    B, S, D = x.shape
    ng, F = scales.shape
    G = D // ng
    s = (lambda x, n, axis: torch.repeat_interleave(x, n, dim=axis))(scales, G, axis=0)
    z = (lambda x, n, axis: torch.repeat_interleave(x, n, dim=axis))(zeros, G, axis=0)
    wq = ((lambda x, dt: x.to(dt))(qw, x.dtype) - z) * s
    xr = torch.einsum("bsd,de->bse", x, U)
    h  = torch.einsum("bse,ef->bsf", xr, wq)
    y  = torch.einsum("bsf,fg->bsg", h, V)
    return y
```

```asm
; @launch grid=(256,1,1) block=(512,1,1) lds=163840
.amdgcn_target "amdgcn-amd-amdhsa--gfx950"
.text
.globl standalone__weight_only_int_quip__prompt_kernel
.p2align 8
.type standalone__weight_only_int_quip__prompt_kernel,@function
standalone__weight_only_int_quip__prompt_kernel:
    s_cmp_ge_u32 s2, 256
    s_cbranch_scc1 L_end
    s_load_dwordx16 s[4:19], s[0:1], 0
    s_load_dwordx2 s[20:21], s[0:1], 64
    v_lshrrev_b32 v2, 6, v0
    v_and_b32 v1, 63, v0
    v_readfirstlane_b32 s52, v2
    s_and_b32 s53, s2, 7
    s_lshr_b32 s54, s2, 3
    v_and_b32 v4, 15, v1
    v_lshrrev_b32 v5, 4, v1
    s_and_b32 s55, s52, 3
    s_lshl_b32 s3, s53, 2
    s_lshr_b32 s96, 1985229328, s3
    s_and_b32 s96, s96, 7
    s_and_b32 s93, s53, 3
    s_lshl_b32 s93, s93, 2
    s_and_b32 s22, s54, 3
    s_add_u32 s93, s93, s22
    s_lshr_b32 s94, s53, 2
    s_lshl_b32 s94, s94, 3
    s_lshr_b32 s3, s54, 2
    s_add_u32 s94, s94, s3
    s_lshl_b32 s22, s22, 1
    s_add_u32 s3, s3, s22
    s_add_u32 s3, s3, s53
    s_and_b32 s3, s3, 7
    s_lshl_b32 s95, s3, 11
    s_cmp_lt_u32 s54, 8
    s_cbranch_scc1 L_idx_x
    s_and_b32 s97, s54, 7
    s_lshr_b32 s98, s54, 3
    s_sub_u32 s98, s98, 1
    s_mov_b32 s56, s97
    s_mul_i32 s57, s53, 3
    s_add_u32 s57, s57, s98
    s_branch L_idx_done
L_idx_x:
    s_and_b32 s56, s54, 3
    s_lshr_b32 s3, s54, 2
    s_lshl_b32 s57, s96, 1
    s_add_u32 s57, s57, s3
L_idx_done:
    s_cmp_ge_u32 s52, 4
    s_cbranch_scc1 L_loader
    s_cmp_lt_u32 s54, 8
    s_cbranch_scc1 L_xr_c
    s_mul_i32 s62, s56, 5
    s_add_u32 s22, s62, s52
    s_add_u32 s62, s62, 4
    v_lshrrev_b32 v2, 2, v1
    v_sub_u32 v3, 4, v5
    v_xor_b32 v3, v3, v1
    v_and_b32 v3, 3, v3
    s_mov_b32 s3, 6144
    v_lshlrev_b32 v6, 4, v3
    v_mad_u32_u24 v6, v2, s3, v6
    s_mul_i32 s58, s22, 98304
    s_lshl_b32 s23, s57, 8
    s_add_u32 s58, s58, s23
    v_lshlrev_b32 v7, 3, v3
    s_lshr_b32 s59, s22, 3
    s_mul_i32 s59, s59, 3072
    s_lshl_b32 s3, s57, 7
    s_add_u32 s59, s59, s3
    s_waitcnt lgkmcnt(0)
    s_mov_b32 s24, s6
    s_mov_b32 s25, s7
    s_mov_b32 s26, 3932160
    s_mov_b32 s27, 0x20000
    buffer_load_dwordx4 v[24:27], v6, s[24:27], s58 offen offset:0
    buffer_load_dwordx4 v[28:31], v6, s[24:27], s58 offen offset:64
    buffer_load_dwordx4 v[32:35], v6, s[24:27], s58 offen offset:128
    buffer_load_dwordx4 v[36:39], v6, s[24:27], s58 offen offset:192
    s_mov_b32 s32, s8
    s_mov_b32 s33, s9
    s_mov_b32 s34, 15360
    s_mov_b32 s35, 0x20000
    s_mov_b32 s36, s10
    s_mov_b32 s37, s11
    s_mov_b32 s38, 15360
    s_mov_b32 s39, 0x20000
    s_mov_b32 s48, s18
    s_mov_b32 s49, s19
    s_mov_b32 s50, 256
    s_mov_b32 s51, 0x20000
    s_mov_b32 s40, s20
    s_mov_b32 s41, s21
    s_mov_b32 s42, 7340032
    s_mov_b32 s43, 0x20000
    s_cmp_ge_u32 s52, 2
    s_cbranch_scc1 L_dq_a
    s_mul_i32 s60, s62, 98304
    s_add_u32 s60, s60, s23
    s_lshl_b32 s23, s52, 7
    s_add_u32 s60, s60, s23
    s_lshr_b32 s61, s62, 3
    s_mul_i32 s61, s61, 3072
    s_add_u32 s61, s61, s3
    s_lshl_b32 s23, s52, 6
    s_add_u32 s61, s61, s23
    buffer_load_dwordx4 v[40:43], v6, s[24:27], s60 offen offset:0
    buffer_load_dwordx4 v[44:47], v6, s[24:27], s60 offen offset:64
    buffer_load_dwordx2 v[56:57], v7, s[32:35], s61 offen offset:0
    buffer_load_dwordx2 v[68:69], v7, s[36:39], s61 offen offset:0
    buffer_load_dwordx2 v[58:59], v7, s[32:35], s61 offen offset:32
    buffer_load_dwordx2 v[70:71], v7, s[36:39], s61 offen offset:32
L_dq_a:
    buffer_load_dwordx2 v[48:49], v7, s[32:35], s59 offen offset:0
    buffer_load_dwordx2 v[60:61], v7, s[36:39], s59 offen offset:0
    buffer_load_dwordx2 v[50:51], v7, s[32:35], s59 offen offset:32
    buffer_load_dwordx2 v[62:63], v7, s[36:39], s59 offen offset:32
    buffer_load_dwordx2 v[52:53], v7, s[32:35], s59 offen offset:64
    buffer_load_dwordx2 v[64:65], v7, s[36:39], s59 offen offset:64
    buffer_load_dwordx2 v[54:55], v7, s[32:35], s59 offen offset:96
    buffer_load_dwordx2 v[66:67], v7, s[36:39], s59 offen offset:96
    s_mul_i32 s58, s22, 49152
    s_lshl_b32 s3, s57, 11
    s_add_u32 s3, s3, 4718592
    s_add_u32 s58, s58, s3
    s_mul_i32 s59, s62, 49152
    s_add_u32 s59, s59, s3
    s_lshl_b32 s3, s52, 10
    s_add_u32 s59, s59, s3
    v_lshlrev_b32 v2, 4, v1
    s_mul_i32 s3, s56, 24
    s_add_u32 s3, s3, s57
    s_lshl_b32 s3, s3, 6
    s_add_u32 s3, s3, s52
    s_lshl_b32 s3, s3, 2
    s_add_u32 s92, s3, 6946816
    s_cmp_ge_u32 s52, 2
    s_cbranch_scc1 L_bt_a
    s_waitcnt vmcnt(17)
    s_branch L_bt_b
L_bt_a:
    s_waitcnt vmcnt(11)
L_bt_b:
    s_barrier
    s_waitcnt vmcnt(0)
    v_mov_b32 v21, 0
    buffer_load_dword v20, v21, s[48:51], 0 offen sc1
    v_lshlrev_b32 v72, 16, v48
    v_and_b32 v73, 0xffff0000, v48
    v_lshlrev_b32 v74, 16, v49
    v_and_b32 v75, 0xffff0000, v49
    v_lshlrev_b32 v76, 16, v60
    v_and_b32 v77, 0xffff0000, v60
    v_lshlrev_b32 v78, 16, v61
    v_and_b32 v79, 0xffff0000, v61
    v_cvt_f32_i32 v24, v24
    v_cvt_f32_i32 v25, v25
    v_cvt_f32_i32 v26, v26
    v_cvt_f32_i32 v27, v27
    v_sub_f32 v24, v24, v76
    v_sub_f32 v25, v25, v77
    v_sub_f32 v26, v26, v78
    v_sub_f32 v27, v27, v79
    v_mul_f32 v24, v24, v72
    v_mul_f32 v25, v25, v73
    v_mul_f32 v26, v26, v74
    v_mul_f32 v27, v27, v75
    v_cvt_pk_bf16_f32 v88, v24, v25
    v_cvt_pk_bf16_f32 v89, v26, v27
    v_lshlrev_b32 v80, 16, v50
    v_and_b32 v81, 0xffff0000, v50
    v_lshlrev_b32 v82, 16, v51
    v_and_b32 v83, 0xffff0000, v51
    v_lshlrev_b32 v84, 16, v62
    v_and_b32 v85, 0xffff0000, v62
    v_lshlrev_b32 v86, 16, v63
    v_and_b32 v87, 0xffff0000, v63
    v_cvt_f32_i32 v28, v28
    v_cvt_f32_i32 v29, v29
    v_cvt_f32_i32 v30, v30
    v_cvt_f32_i32 v31, v31
    v_sub_f32 v28, v28, v84
    v_sub_f32 v29, v29, v85
    v_sub_f32 v30, v30, v86
    v_sub_f32 v31, v31, v87
    v_mul_f32 v28, v28, v80
    v_mul_f32 v29, v29, v81
    v_mul_f32 v30, v30, v82
    v_mul_f32 v31, v31, v83
    v_cvt_pk_bf16_f32 v90, v28, v29
    v_cvt_pk_bf16_f32 v91, v30, v31
    buffer_store_dwordx4 v[88:91], v2, s[40:43], s58 offen offset:0 sc1
    v_lshlrev_b32 v72, 16, v52
    v_and_b32 v73, 0xffff0000, v52
    v_lshlrev_b32 v74, 16, v53
    v_and_b32 v75, 0xffff0000, v53
    v_lshlrev_b32 v76, 16, v64
    v_and_b32 v77, 0xffff0000, v64
    v_lshlrev_b32 v78, 16, v65
    v_and_b32 v79, 0xffff0000, v65
    v_cvt_f32_i32 v32, v32
    v_cvt_f32_i32 v33, v33
    v_cvt_f32_i32 v34, v34
    v_cvt_f32_i32 v35, v35
    v_sub_f32 v32, v32, v76
    v_sub_f32 v33, v33, v77
    v_sub_f32 v34, v34, v78
    v_sub_f32 v35, v35, v79
    v_mul_f32 v32, v32, v72
    v_mul_f32 v33, v33, v73
    v_mul_f32 v34, v34, v74
    v_mul_f32 v35, v35, v75
    v_cvt_pk_bf16_f32 v92, v32, v33
    v_cvt_pk_bf16_f32 v93, v34, v35
    v_lshlrev_b32 v80, 16, v54
    v_and_b32 v81, 0xffff0000, v54
    v_lshlrev_b32 v82, 16, v55
    v_and_b32 v83, 0xffff0000, v55
    v_lshlrev_b32 v84, 16, v66
    v_and_b32 v85, 0xffff0000, v66
    v_lshlrev_b32 v86, 16, v67
    v_and_b32 v87, 0xffff0000, v67
    v_cvt_f32_i32 v36, v36
    v_cvt_f32_i32 v37, v37
    v_cvt_f32_i32 v38, v38
    v_cvt_f32_i32 v39, v39
    v_sub_f32 v36, v36, v84
    v_sub_f32 v37, v37, v85
    v_sub_f32 v38, v38, v86
    v_sub_f32 v39, v39, v87
    v_mul_f32 v36, v36, v80
    v_mul_f32 v37, v37, v81
    v_mul_f32 v38, v38, v82
    v_mul_f32 v39, v39, v83
    v_cvt_pk_bf16_f32 v94, v36, v37
    v_cvt_pk_bf16_f32 v95, v38, v39
    buffer_store_dwordx4 v[92:95], v2, s[40:43], s58 offen offset:1024 sc1
    s_cbranch_scc1 L_dq_b
    v_lshlrev_b32 v72, 16, v56
    v_and_b32 v73, 0xffff0000, v56
    v_lshlrev_b32 v74, 16, v57
    v_and_b32 v75, 0xffff0000, v57
    v_lshlrev_b32 v76, 16, v68
    v_and_b32 v77, 0xffff0000, v68
    v_lshlrev_b32 v78, 16, v69
    v_and_b32 v79, 0xffff0000, v69
    v_cvt_f32_i32 v40, v40
    v_cvt_f32_i32 v41, v41
    v_cvt_f32_i32 v42, v42
    v_cvt_f32_i32 v43, v43
    v_sub_f32 v40, v40, v76
    v_sub_f32 v41, v41, v77
    v_sub_f32 v42, v42, v78
    v_sub_f32 v43, v43, v79
    v_mul_f32 v40, v40, v72
    v_mul_f32 v41, v41, v73
    v_mul_f32 v42, v42, v74
    v_mul_f32 v43, v43, v75
    v_cvt_pk_bf16_f32 v96, v40, v41
    v_cvt_pk_bf16_f32 v97, v42, v43
    v_lshlrev_b32 v80, 16, v58
    v_and_b32 v81, 0xffff0000, v58
    v_lshlrev_b32 v82, 16, v59
    v_and_b32 v83, 0xffff0000, v59
    v_lshlrev_b32 v84, 16, v70
    v_and_b32 v85, 0xffff0000, v70
    v_lshlrev_b32 v86, 16, v71
    v_and_b32 v87, 0xffff0000, v71
    v_cvt_f32_i32 v44, v44
    v_cvt_f32_i32 v45, v45
    v_cvt_f32_i32 v46, v46
    v_cvt_f32_i32 v47, v47
    v_sub_f32 v44, v44, v84
    v_sub_f32 v45, v45, v85
    v_sub_f32 v46, v46, v86
    v_sub_f32 v47, v47, v87
    v_mul_f32 v44, v44, v80
    v_mul_f32 v45, v45, v81
    v_mul_f32 v46, v46, v82
    v_mul_f32 v47, v47, v83
    v_cvt_pk_bf16_f32 v98, v44, v45
    v_cvt_pk_bf16_f32 v99, v46, v47
    buffer_store_dwordx4 v[96:99], v2, s[40:43], s59 offen sc1
L_dq_b:
    s_lshr_b32 s22, s52, 1
    s_and_b32 s23, s52, 1
    v_lshrrev_b32 v2, 2, v4
    v_and_b32 v3, 1, v5
    v_lshrrev_b32 v6, 1, v2
    v_lshl_add_u32 v3, v3, 1, v6
    v_lshlrev_b32 v3, 1, v3
    v_bfe_u32 v6, v1, 1, 1
    s_lshl_b32 s3, s23, 2
    s_lshl_b32 s58, s22, 1
    s_add_u32 s3, s3, s58
    v_add_u32 v6, s3, v6
    v_xor_b32 v6, v6, v3
    v_lshlrev_b32 v6, 4, v6
    v_and_b32 v3, 1, v1
    v_lshl_add_u32 v6, v3, 3, v6
    v_lshl_add_u32 v2, v5, 2, v2
    v_lshl_add_u32 v6, v2, 7, v6
    s_lshl_b32 s3, s22, 12
    v_add_u32 v6, s3, v6
    v_xor_b32 v7, 32, v6
    v_add_u32 v8, 0x10000, v6
    v_add_u32 v9, 0x10000, v7
    v_add_u32 v10, 0x20000, v6
    v_add_u32 v11, 0x20000, v7
    v_lshrrev_b32 v2, 2, v4
    v_sub_u32 v2, 4, v2
    v_xor_b32 v2, v2, v5
    v_and_b32 v2, 3, v2
    v_lshl_add_u32 v2, v4, 2, v2
    v_lshlrev_b32 v2, 4, v2
    s_mul_i32 s3, s22, 5120
    s_add_u32 s3, s3, 32768
    v_add_u32 v12, s3, v2
    v_add_u32 v13, 61440, v12
    s_waitcnt vmcnt(0)
    s_mov_b32 s91, 0
Lnon_1:
    v_readfirstlane_b32 s90, v20
    s_add_u32 s91, s91, 1
    s_cmp_lg_u32 s90, 0
    s_cbranch_scc1 Lnon_2
    s_cmp_gt_u32 s91, 0x100000
    s_cbranch_scc1 L_end
    buffer_load_dword v20, v21, s[48:51], 0 offen sc1
    s_waitcnt vmcnt(0)
    s_branch Lnon_1
Lnon_2:
    v_mov_b32 v21, s92
    s_mov_b64 exec, 1
    buffer_store_dword v20, v21, s[40:43], 0 offen sc1
    s_mov_b64 exec, -1
    s_barrier
    ds_read_b64_tr_b16 a[0:1], v6 offset:0
    ds_read_b64_tr_b16 a[2:3], v6 offset:2048
    ds_read_b64_tr_b16 a[4:5], v7 offset:0
    ds_read_b64_tr_b16 a[6:7], v7 offset:2048
    ds_read_b64_tr_b16 a[8:9], v6 offset:8192
    ds_read_b64_tr_b16 a[10:11], v6 offset:10240
    ds_read_b64_tr_b16 a[12:13], v7 offset:8192
    ds_read_b64_tr_b16 a[14:15], v7 offset:10240
    ds_read_b64_tr_b16 a[16:17], v6 offset:16384
    ds_read_b64_tr_b16 a[18:19], v6 offset:18432
    ds_read_b64_tr_b16 a[20:21], v7 offset:16384
    ds_read_b64_tr_b16 a[22:23], v7 offset:18432
    ds_read_b64_tr_b16 a[24:25], v6 offset:24576
    ds_read_b64_tr_b16 a[26:27], v6 offset:26624
    ds_read_b64_tr_b16 a[28:29], v7 offset:24576
    ds_read_b64_tr_b16 a[30:31], v7 offset:26624
    s_waitcnt  lgkmcnt(0)
    s_barrier
    ds_read_b64_tr_b16 a[32:33], v6 offset:32768
    ds_read_b64_tr_b16 a[34:35], v6 offset:34816
    ds_read_b64_tr_b16 a[36:37], v7 offset:32768
    ds_read_b64_tr_b16 a[38:39], v7 offset:34816
    ds_read_b64_tr_b16 a[40:41], v6 offset:40960
    ds_read_b64_tr_b16 a[42:43], v6 offset:43008
    ds_read_b64_tr_b16 a[44:45], v7 offset:40960
    ds_read_b64_tr_b16 a[46:47], v7 offset:43008
    ds_read_b64_tr_b16 a[48:49], v6 offset:49152
    ds_read_b64_tr_b16 a[50:51], v6 offset:51200
    ds_read_b64_tr_b16 a[52:53], v7 offset:49152
    ds_read_b64_tr_b16 a[54:55], v7 offset:51200
    ds_read_b64_tr_b16 a[56:57], v6 offset:57344
    ds_read_b64_tr_b16 a[58:59], v6 offset:59392
    ds_read_b64_tr_b16 a[60:61], v7 offset:57344
    ds_read_b64_tr_b16 a[62:63], v7 offset:59392
    ds_read_b64_tr_b16 a[64:65], v8 offset:0
    ds_read_b64_tr_b16 a[66:67], v8 offset:2048
    ds_read_b64_tr_b16 a[68:69], v9 offset:0
    ds_read_b64_tr_b16 a[70:71], v9 offset:2048
    ds_read_b64_tr_b16 a[72:73], v8 offset:8192
    ds_read_b64_tr_b16 a[74:75], v8 offset:10240
    ds_read_b64_tr_b16 a[76:77], v9 offset:8192
    ds_read_b64_tr_b16 a[78:79], v9 offset:10240
    ds_read_b64_tr_b16 a[80:81], v8 offset:16384
    ds_read_b64_tr_b16 a[82:83], v8 offset:18432
    ds_read_b64_tr_b16 a[84:85], v9 offset:16384
    ds_read_b64_tr_b16 a[86:87], v9 offset:18432
    ds_read_b64_tr_b16 a[88:89], v8 offset:24576
    ds_read_b64_tr_b16 a[90:91], v8 offset:26624
    ds_read_b64_tr_b16 a[92:93], v9 offset:24576
    ds_read_b64_tr_b16 a[94:95], v9 offset:26624
    s_waitcnt  lgkmcnt(0)
    s_barrier
    ds_read_b64_tr_b16 a[96:97], v8 offset:32768
    ds_read_b64_tr_b16 a[98:99], v8 offset:34816
    ds_read_b64_tr_b16 a[100:101], v9 offset:32768
    ds_read_b64_tr_b16 a[102:103], v9 offset:34816
    ds_read_b64_tr_b16 a[104:105], v8 offset:40960
    ds_read_b64_tr_b16 a[106:107], v8 offset:43008
    ds_read_b64_tr_b16 a[108:109], v9 offset:40960
    ds_read_b64_tr_b16 a[110:111], v9 offset:43008
    ds_read_b64_tr_b16 a[112:113], v8 offset:49152
    ds_read_b64_tr_b16 a[114:115], v8 offset:51200
    ds_read_b64_tr_b16 a[116:117], v9 offset:49152
    ds_read_b64_tr_b16 a[118:119], v9 offset:51200
    ds_read_b64_tr_b16 a[120:121], v8 offset:57344
    ds_read_b64_tr_b16 a[122:123], v8 offset:59392
    ds_read_b64_tr_b16 a[124:125], v9 offset:57344
    ds_read_b64_tr_b16 a[126:127], v9 offset:59392
    ds_read_b64_tr_b16 a[128:129], v10 offset:0
    ds_read_b64_tr_b16 a[130:131], v10 offset:2048
    ds_read_b64_tr_b16 a[132:133], v11 offset:0
    ds_read_b64_tr_b16 a[134:135], v11 offset:2048
    ds_read_b64_tr_b16 a[136:137], v10 offset:8192
    ds_read_b64_tr_b16 a[138:139], v10 offset:10240
    ds_read_b64_tr_b16 a[140:141], v11 offset:8192
    ds_read_b64_tr_b16 a[142:143], v11 offset:10240
    ds_read_b64_tr_b16 v[96:97], v10 offset:16384
    ds_read_b64_tr_b16 v[98:99], v10 offset:18432
    ds_read_b64_tr_b16 v[100:101], v11 offset:16384
    ds_read_b64_tr_b16 v[102:103], v11 offset:18432
    ds_read_b64_tr_b16 v[104:105], v10 offset:24576
    ds_read_b64_tr_b16 v[106:107], v10 offset:26624
    ds_read_b64_tr_b16 v[108:109], v11 offset:24576
    ds_read_b64_tr_b16 v[110:111], v11 offset:26624
    s_waitcnt  lgkmcnt(0)
    s_barrier
    ds_read_b128 v[24:27], v12 offset:0
    ds_read_b128 v[28:31], v12 offset:1024
    ds_read_b128 v[32:35], v12 offset:2048
    ds_read_b128 v[36:39], v12 offset:3072
    ds_read_b128 v[40:43], v12 offset:4096
    s_waitcnt lgkmcnt(4)
    v_mfma_f32_16x16x32_bf16 v[44:47], v[24:27], a[0:3], 0
    v_mfma_f32_16x16x32_bf16 v[48:51], v[24:27], a[4:7], 0
    ds_read_b128 v[24:27], v12 offset:10240
    s_waitcnt lgkmcnt(4)
    v_mfma_f32_16x16x32_bf16 v[52:55], v[28:31], a[0:3], 0
    v_mfma_f32_16x16x32_bf16 v[56:59], v[28:31], a[4:7], 0
    ds_read_b128 v[28:31], v12 offset:11264
    s_waitcnt lgkmcnt(4)
    v_mfma_f32_16x16x32_bf16 v[60:63], v[32:35], a[0:3], 0
    v_mfma_f32_16x16x32_bf16 v[64:67], v[32:35], a[4:7], 0
    ds_read_b128 v[32:35], v12 offset:12288
    s_waitcnt lgkmcnt(4)
    v_mfma_f32_16x16x32_bf16 v[68:71], v[36:39], a[0:3], 0
    v_mfma_f32_16x16x32_bf16 v[72:75], v[36:39], a[4:7], 0
    ds_read_b128 v[36:39], v12 offset:13312
    s_waitcnt lgkmcnt(4)
    v_mfma_f32_16x16x32_bf16 v[76:79], v[40:43], a[0:3], 0
    v_mfma_f32_16x16x32_bf16 v[80:83], v[40:43], a[4:7], 0
    ds_read_b128 v[40:43], v12 offset:14336
    s_waitcnt lgkmcnt(4)
    v_mfma_f32_16x16x32_bf16 v[44:47], v[24:27], a[8:11], v[44:47]
    v_mfma_f32_16x16x32_bf16 v[48:51], v[24:27], a[12:15], v[48:51]
    s_barrier
    ds_read_b128 v[24:27], v12 offset:20480
    s_waitcnt lgkmcnt(4)
    v_mfma_f32_16x16x32_bf16 v[52:55], v[28:31], a[8:11], v[52:55]
    v_mfma_f32_16x16x32_bf16 v[56:59], v[28:31], a[12:15], v[56:59]
    ds_read_b128 v[28:31], v12 offset:21504
    s_waitcnt lgkmcnt(4)
    v_mfma_f32_16x16x32_bf16 v[60:63], v[32:35], a[8:11], v[60:63]
    v_mfma_f32_16x16x32_bf16 v[64:67], v[32:35], a[12:15], v[64:67]
    ds_read_b128 v[32:35], v12 offset:22528
    s_waitcnt lgkmcnt(4)
    v_mfma_f32_16x16x32_bf16 v[68:71], v[36:39], a[8:11], v[68:71]
    v_mfma_f32_16x16x32_bf16 v[72:75], v[36:39], a[12:15], v[72:75]
    ds_read_b128 v[36:39], v12 offset:23552
    s_waitcnt lgkmcnt(4)
    v_mfma_f32_16x16x32_bf16 v[76:79], v[40:43], a[8:11], v[76:79]
    v_mfma_f32_16x16x32_bf16 v[80:83], v[40:43], a[12:15], v[80:83]
    ds_read_b128 v[40:43], v12 offset:24576
    s_waitcnt lgkmcnt(4)
    v_mfma_f32_16x16x32_bf16 v[44:47], v[24:27], a[16:19], v[44:47]
    v_mfma_f32_16x16x32_bf16 v[48:51], v[24:27], a[20:23], v[48:51]
    ds_read_b128 v[24:27], v12 offset:30720
    s_waitcnt lgkmcnt(4)
    v_mfma_f32_16x16x32_bf16 v[52:55], v[28:31], a[16:19], v[52:55]
    v_mfma_f32_16x16x32_bf16 v[56:59], v[28:31], a[20:23], v[56:59]
    ds_read_b128 v[28:31], v12 offset:31744
    s_waitcnt lgkmcnt(4)
    v_mfma_f32_16x16x32_bf16 v[60:63], v[32:35], a[16:19], v[60:63]
    v_mfma_f32_16x16x32_bf16 v[64:67], v[32:35], a[20:23], v[64:67]
    ds_read_b128 v[32:35], v12 offset:32768
    s_waitcnt lgkmcnt(4)
    v_mfma_f32_16x16x32_bf16 v[68:71], v[36:39], a[16:19], v[68:71]
    v_mfma_f32_16x16x32_bf16 v[72:75], v[36:39], a[20:23], v[72:75]
    ds_read_b128 v[36:39], v12 offset:33792
    s_waitcnt lgkmcnt(4)
    v_mfma_f32_16x16x32_bf16 v[76:79], v[40:43], a[16:19], v[76:79]
    v_mfma_f32_16x16x32_bf16 v[80:83], v[40:43], a[20:23], v[80:83]
    ds_read_b128 v[40:43], v12 offset:34816
    s_waitcnt lgkmcnt(4)
    v_mfma_f32_16x16x32_bf16 v[44:47], v[24:27], a[24:27], v[44:47]
    v_mfma_f32_16x16x32_bf16 v[48:51], v[24:27], a[28:31], v[48:51]
    s_barrier
    ds_read_b128 v[24:27], v12 offset:40960
    s_waitcnt lgkmcnt(4)
    v_mfma_f32_16x16x32_bf16 v[52:55], v[28:31], a[24:27], v[52:55]
    v_mfma_f32_16x16x32_bf16 v[56:59], v[28:31], a[28:31], v[56:59]
    ds_read_b128 v[28:31], v12 offset:41984
    s_waitcnt lgkmcnt(4)
    v_mfma_f32_16x16x32_bf16 v[60:63], v[32:35], a[24:27], v[60:63]
    v_mfma_f32_16x16x32_bf16 v[64:67], v[32:35], a[28:31], v[64:67]
    ds_read_b128 v[32:35], v12 offset:43008
    s_waitcnt lgkmcnt(4)
    v_mfma_f32_16x16x32_bf16 v[68:71], v[36:39], a[24:27], v[68:71]
    v_mfma_f32_16x16x32_bf16 v[72:75], v[36:39], a[28:31], v[72:75]
    ds_read_b128 v[36:39], v12 offset:44032
    s_waitcnt lgkmcnt(4)
    v_mfma_f32_16x16x32_bf16 v[76:79], v[40:43], a[24:27], v[76:79]
    v_mfma_f32_16x16x32_bf16 v[80:83], v[40:43], a[28:31], v[80:83]
    ds_read_b128 v[40:43], v12 offset:45056
    s_waitcnt lgkmcnt(4)
    v_mfma_f32_16x16x32_bf16 v[44:47], v[24:27], a[32:35], v[44:47]
    v_mfma_f32_16x16x32_bf16 v[48:51], v[24:27], a[36:39], v[48:51]
    ds_read_b128 v[24:27], v12 offset:51200
    s_waitcnt lgkmcnt(4)
    v_mfma_f32_16x16x32_bf16 v[52:55], v[28:31], a[32:35], v[52:55]
    v_mfma_f32_16x16x32_bf16 v[56:59], v[28:31], a[36:39], v[56:59]
    ds_read_b128 v[28:31], v12 offset:52224
    s_waitcnt lgkmcnt(4)
    v_mfma_f32_16x16x32_bf16 v[60:63], v[32:35], a[32:35], v[60:63]
    v_mfma_f32_16x16x32_bf16 v[64:67], v[32:35], a[36:39], v[64:67]
    ds_read_b128 v[32:35], v12 offset:53248
    s_waitcnt lgkmcnt(4)
    v_mfma_f32_16x16x32_bf16 v[68:71], v[36:39], a[32:35], v[68:71]
    v_mfma_f32_16x16x32_bf16 v[72:75], v[36:39], a[36:39], v[72:75]
    ds_read_b128 v[36:39], v12 offset:54272
    s_waitcnt lgkmcnt(4)
    v_mfma_f32_16x16x32_bf16 v[76:79], v[40:43], a[32:35], v[76:79]
    v_mfma_f32_16x16x32_bf16 v[80:83], v[40:43], a[36:39], v[80:83]
    ds_read_b128 v[40:43], v12 offset:55296
    s_waitcnt lgkmcnt(4)
    v_mfma_f32_16x16x32_bf16 v[44:47], v[24:27], a[40:43], v[44:47]
    v_mfma_f32_16x16x32_bf16 v[48:51], v[24:27], a[44:47], v[48:51]
    s_barrier
    ds_read_b128 v[24:27], v13 offset:0
    s_waitcnt lgkmcnt(4)
    v_mfma_f32_16x16x32_bf16 v[52:55], v[28:31], a[40:43], v[52:55]
    v_mfma_f32_16x16x32_bf16 v[56:59], v[28:31], a[44:47], v[56:59]
    ds_read_b128 v[28:31], v13 offset:1024
    s_waitcnt lgkmcnt(4)
    v_mfma_f32_16x16x32_bf16 v[60:63], v[32:35], a[40:43], v[60:63]
    v_mfma_f32_16x16x32_bf16 v[64:67], v[32:35], a[44:47], v[64:67]
    ds_read_b128 v[32:35], v13 offset:2048
    s_waitcnt lgkmcnt(4)
    v_mfma_f32_16x16x32_bf16 v[68:71], v[36:39], a[40:43], v[68:71]
    v_mfma_f32_16x16x32_bf16 v[72:75], v[36:39], a[44:47], v[72:75]
    ds_read_b128 v[36:39], v13 offset:3072
    s_waitcnt lgkmcnt(4)
    v_mfma_f32_16x16x32_bf16 v[76:79], v[40:43], a[40:43], v[76:79]
    v_mfma_f32_16x16x32_bf16 v[80:83], v[40:43], a[44:47], v[80:83]
    ds_read_b128 v[40:43], v13 offset:4096
    s_waitcnt lgkmcnt(4)
    v_mfma_f32_16x16x32_bf16 v[44:47], v[24:27], a[48:51], v[44:47]
    v_mfma_f32_16x16x32_bf16 v[48:51], v[24:27], a[52:55], v[48:51]
    ds_read_b128 v[24:27], v13 offset:10240
    s_waitcnt lgkmcnt(4)
    v_mfma_f32_16x16x32_bf16 v[52:55], v[28:31], a[48:51], v[52:55]
    v_mfma_f32_16x16x32_bf16 v[56:59], v[28:31], a[52:55], v[56:59]
    ds_read_b128 v[28:31], v13 offset:11264
    s_waitcnt lgkmcnt(4)
    v_mfma_f32_16x16x32_bf16 v[60:63], v[32:35], a[48:51], v[60:63]
    v_mfma_f32_16x16x32_bf16 v[64:67], v[32:35], a[52:55], v[64:67]
    ds_read_b128 v[32:35], v13 offset:12288
    s_waitcnt lgkmcnt(4)
    v_mfma_f32_16x16x32_bf16 v[68:71], v[36:39], a[48:51], v[68:71]
    v_mfma_f32_16x16x32_bf16 v[72:75], v[36:39], a[52:55], v[72:75]
    ds_read_b128 v[36:39], v13 offset:13312
    s_waitcnt lgkmcnt(4)
    v_mfma_f32_16x16x32_bf16 v[76:79], v[40:43], a[48:51], v[76:79]
    v_mfma_f32_16x16x32_bf16 v[80:83], v[40:43], a[52:55], v[80:83]
    ds_read_b128 v[40:43], v13 offset:14336
    s_waitcnt lgkmcnt(4)
    v_mfma_f32_16x16x32_bf16 v[44:47], v[24:27], a[56:59], v[44:47]
    v_mfma_f32_16x16x32_bf16 v[48:51], v[24:27], a[60:63], v[48:51]
    s_barrier
    ds_read_b128 v[24:27], v13 offset:20480
    s_waitcnt lgkmcnt(4)
    v_mfma_f32_16x16x32_bf16 v[52:55], v[28:31], a[56:59], v[52:55]
    v_mfma_f32_16x16x32_bf16 v[56:59], v[28:31], a[60:63], v[56:59]
    ds_read_b128 v[28:31], v13 offset:21504
    s_waitcnt lgkmcnt(4)
    v_mfma_f32_16x16x32_bf16 v[60:63], v[32:35], a[56:59], v[60:63]
    v_mfma_f32_16x16x32_bf16 v[64:67], v[32:35], a[60:63], v[64:67]
    ds_read_b128 v[32:35], v13 offset:22528
    s_waitcnt lgkmcnt(4)
    v_mfma_f32_16x16x32_bf16 v[68:71], v[36:39], a[56:59], v[68:71]
    v_mfma_f32_16x16x32_bf16 v[72:75], v[36:39], a[60:63], v[72:75]
    ds_read_b128 v[36:39], v13 offset:23552
    s_waitcnt lgkmcnt(4)
    v_mfma_f32_16x16x32_bf16 v[76:79], v[40:43], a[56:59], v[76:79]
    v_mfma_f32_16x16x32_bf16 v[80:83], v[40:43], a[60:63], v[80:83]
    ds_read_b128 v[40:43], v13 offset:24576
    s_waitcnt lgkmcnt(4)
    v_mfma_f32_16x16x32_bf16 v[44:47], v[24:27], a[64:67], v[44:47]
    v_mfma_f32_16x16x32_bf16 v[48:51], v[24:27], a[68:71], v[48:51]
    ds_read_b128 v[24:27], v13 offset:30720
    s_waitcnt lgkmcnt(4)
    v_mfma_f32_16x16x32_bf16 v[52:55], v[28:31], a[64:67], v[52:55]
    v_mfma_f32_16x16x32_bf16 v[56:59], v[28:31], a[68:71], v[56:59]
    ds_read_b128 v[28:31], v13 offset:31744
    s_waitcnt lgkmcnt(4)
    v_mfma_f32_16x16x32_bf16 v[60:63], v[32:35], a[64:67], v[60:63]
    v_mfma_f32_16x16x32_bf16 v[64:67], v[32:35], a[68:71], v[64:67]
    ds_read_b128 v[32:35], v13 offset:32768
    s_waitcnt lgkmcnt(4)
    v_mfma_f32_16x16x32_bf16 v[68:71], v[36:39], a[64:67], v[68:71]
    v_mfma_f32_16x16x32_bf16 v[72:75], v[36:39], a[68:71], v[72:75]
    ds_read_b128 v[36:39], v13 offset:33792
    s_waitcnt lgkmcnt(4)
    v_mfma_f32_16x16x32_bf16 v[76:79], v[40:43], a[64:67], v[76:79]
    v_mfma_f32_16x16x32_bf16 v[80:83], v[40:43], a[68:71], v[80:83]
    ds_read_b128 v[40:43], v13 offset:34816
    s_waitcnt lgkmcnt(4)
    v_mfma_f32_16x16x32_bf16 v[44:47], v[24:27], a[72:75], v[44:47]
    v_mfma_f32_16x16x32_bf16 v[48:51], v[24:27], a[76:79], v[48:51]
    s_barrier
    ds_read_b128 v[24:27], v13 offset:40960
    s_waitcnt lgkmcnt(4)
    v_mfma_f32_16x16x32_bf16 v[52:55], v[28:31], a[72:75], v[52:55]
    v_mfma_f32_16x16x32_bf16 v[56:59], v[28:31], a[76:79], v[56:59]
    ds_read_b128 v[28:31], v13 offset:41984
    s_waitcnt lgkmcnt(4)
    v_mfma_f32_16x16x32_bf16 v[60:63], v[32:35], a[72:75], v[60:63]
    v_mfma_f32_16x16x32_bf16 v[64:67], v[32:35], a[76:79], v[64:67]
    ds_read_b128 v[32:35], v13 offset:43008
    s_waitcnt lgkmcnt(4)
    v_mfma_f32_16x16x32_bf16 v[68:71], v[36:39], a[72:75], v[68:71]
    v_mfma_f32_16x16x32_bf16 v[72:75], v[36:39], a[76:79], v[72:75]
    ds_read_b128 v[36:39], v13 offset:44032
    s_waitcnt lgkmcnt(4)
    v_mfma_f32_16x16x32_bf16 v[76:79], v[40:43], a[72:75], v[76:79]
    v_mfma_f32_16x16x32_bf16 v[80:83], v[40:43], a[76:79], v[80:83]
    ds_read_b128 v[40:43], v13 offset:45056
    s_waitcnt lgkmcnt(4)
    v_mfma_f32_16x16x32_bf16 v[44:47], v[24:27], a[80:83], v[44:47]
    v_mfma_f32_16x16x32_bf16 v[48:51], v[24:27], a[84:87], v[48:51]
    ds_read_b128 v[24:27], v13 offset:51200
    s_waitcnt lgkmcnt(4)
    v_mfma_f32_16x16x32_bf16 v[52:55], v[28:31], a[80:83], v[52:55]
    v_mfma_f32_16x16x32_bf16 v[56:59], v[28:31], a[84:87], v[56:59]
    ds_read_b128 v[28:31], v13 offset:52224
    s_waitcnt lgkmcnt(4)
    v_mfma_f32_16x16x32_bf16 v[60:63], v[32:35], a[80:83], v[60:63]
    v_mfma_f32_16x16x32_bf16 v[64:67], v[32:35], a[84:87], v[64:67]
    ds_read_b128 v[32:35], v13 offset:53248
    s_waitcnt lgkmcnt(4)
    v_mfma_f32_16x16x32_bf16 v[68:71], v[36:39], a[80:83], v[68:71]
    v_mfma_f32_16x16x32_bf16 v[72:75], v[36:39], a[84:87], v[72:75]
    ds_read_b128 v[36:39], v13 offset:54272
    s_waitcnt lgkmcnt(4)
    v_mfma_f32_16x16x32_bf16 v[76:79], v[40:43], a[80:83], v[76:79]
    v_mfma_f32_16x16x32_bf16 v[80:83], v[40:43], a[84:87], v[80:83]
    ds_read_b128 v[40:43], v13 offset:55296
    s_waitcnt lgkmcnt(4)
    v_mfma_f32_16x16x32_bf16 v[44:47], v[24:27], a[88:91], v[44:47]
    v_mfma_f32_16x16x32_bf16 v[48:51], v[24:27], a[92:95], v[48:51]
    s_barrier
    ds_read_b128 v[24:27], v12 offset:0
    s_waitcnt lgkmcnt(4)
    v_mfma_f32_16x16x32_bf16 v[52:55], v[28:31], a[88:91], v[52:55]
    v_mfma_f32_16x16x32_bf16 v[56:59], v[28:31], a[92:95], v[56:59]
    ds_read_b128 v[28:31], v12 offset:1024
    s_waitcnt lgkmcnt(4)
    v_mfma_f32_16x16x32_bf16 v[60:63], v[32:35], a[88:91], v[60:63]
    v_mfma_f32_16x16x32_bf16 v[64:67], v[32:35], a[92:95], v[64:67]
    ds_read_b128 v[32:35], v12 offset:2048
    s_waitcnt lgkmcnt(4)
    v_mfma_f32_16x16x32_bf16 v[68:71], v[36:39], a[88:91], v[68:71]
    v_mfma_f32_16x16x32_bf16 v[72:75], v[36:39], a[92:95], v[72:75]
    ds_read_b128 v[36:39], v12 offset:3072
    s_waitcnt lgkmcnt(4)
    v_mfma_f32_16x16x32_bf16 v[76:79], v[40:43], a[88:91], v[76:79]
    v_mfma_f32_16x16x32_bf16 v[80:83], v[40:43], a[92:95], v[80:83]
    ds_read_b128 v[40:43], v12 offset:4096
    s_waitcnt lgkmcnt(4)
    v_mfma_f32_16x16x32_bf16 v[44:47], v[24:27], a[96:99], v[44:47]
    v_mfma_f32_16x16x32_bf16 v[48:51], v[24:27], a[100:103], v[48:51]
    ds_read_b128 v[24:27], v12 offset:10240
    s_waitcnt lgkmcnt(4)
    v_mfma_f32_16x16x32_bf16 v[52:55], v[28:31], a[96:99], v[52:55]
    v_mfma_f32_16x16x32_bf16 v[56:59], v[28:31], a[100:103], v[56:59]
    ds_read_b128 v[28:31], v12 offset:11264
    s_waitcnt lgkmcnt(4)
    v_mfma_f32_16x16x32_bf16 v[60:63], v[32:35], a[96:99], v[60:63]
    v_mfma_f32_16x16x32_bf16 v[64:67], v[32:35], a[100:103], v[64:67]
    ds_read_b128 v[32:35], v12 offset:12288
    s_waitcnt lgkmcnt(4)
    v_mfma_f32_16x16x32_bf16 v[68:71], v[36:39], a[96:99], v[68:71]
    v_mfma_f32_16x16x32_bf16 v[72:75], v[36:39], a[100:103], v[72:75]
    ds_read_b128 v[36:39], v12 offset:13312
    s_waitcnt lgkmcnt(4)
    v_mfma_f32_16x16x32_bf16 v[76:79], v[40:43], a[96:99], v[76:79]
    v_mfma_f32_16x16x32_bf16 v[80:83], v[40:43], a[100:103], v[80:83]
    ds_read_b128 v[40:43], v12 offset:14336
    s_waitcnt lgkmcnt(4)
    v_mfma_f32_16x16x32_bf16 v[44:47], v[24:27], a[104:107], v[44:47]
    v_mfma_f32_16x16x32_bf16 v[48:51], v[24:27], a[108:111], v[48:51]
    s_barrier
    ds_read_b128 v[24:27], v12 offset:20480
    s_waitcnt lgkmcnt(4)
    v_mfma_f32_16x16x32_bf16 v[52:55], v[28:31], a[104:107], v[52:55]
    v_mfma_f32_16x16x32_bf16 v[56:59], v[28:31], a[108:111], v[56:59]
    ds_read_b128 v[28:31], v12 offset:21504
    s_waitcnt lgkmcnt(4)
    v_mfma_f32_16x16x32_bf16 v[60:63], v[32:35], a[104:107], v[60:63]
    v_mfma_f32_16x16x32_bf16 v[64:67], v[32:35], a[108:111], v[64:67]
    ds_read_b128 v[32:35], v12 offset:22528
    s_waitcnt lgkmcnt(4)
    v_mfma_f32_16x16x32_bf16 v[68:71], v[36:39], a[104:107], v[68:71]
    v_mfma_f32_16x16x32_bf16 v[72:75], v[36:39], a[108:111], v[72:75]
    ds_read_b128 v[36:39], v12 offset:23552
    s_waitcnt lgkmcnt(4)
    v_mfma_f32_16x16x32_bf16 v[76:79], v[40:43], a[104:107], v[76:79]
    v_mfma_f32_16x16x32_bf16 v[80:83], v[40:43], a[108:111], v[80:83]
    ds_read_b128 v[40:43], v12 offset:24576
    s_waitcnt lgkmcnt(4)
    v_mfma_f32_16x16x32_bf16 v[44:47], v[24:27], a[112:115], v[44:47]
    v_mfma_f32_16x16x32_bf16 v[48:51], v[24:27], a[116:119], v[48:51]
    ds_read_b128 v[24:27], v12 offset:30720
    s_waitcnt lgkmcnt(4)
    v_mfma_f32_16x16x32_bf16 v[52:55], v[28:31], a[112:115], v[52:55]
    v_mfma_f32_16x16x32_bf16 v[56:59], v[28:31], a[116:119], v[56:59]
    ds_read_b128 v[28:31], v12 offset:31744
    s_waitcnt lgkmcnt(4)
    v_mfma_f32_16x16x32_bf16 v[60:63], v[32:35], a[112:115], v[60:63]
    v_mfma_f32_16x16x32_bf16 v[64:67], v[32:35], a[116:119], v[64:67]
    ds_read_b128 v[32:35], v12 offset:32768
    s_waitcnt lgkmcnt(4)
    v_mfma_f32_16x16x32_bf16 v[68:71], v[36:39], a[112:115], v[68:71]
    v_mfma_f32_16x16x32_bf16 v[72:75], v[36:39], a[116:119], v[72:75]
    ds_read_b128 v[36:39], v12 offset:33792
    s_waitcnt lgkmcnt(4)
    v_mfma_f32_16x16x32_bf16 v[76:79], v[40:43], a[112:115], v[76:79]
    v_mfma_f32_16x16x32_bf16 v[80:83], v[40:43], a[116:119], v[80:83]
    ds_read_b128 v[40:43], v12 offset:34816
    s_waitcnt lgkmcnt(4)
    v_mfma_f32_16x16x32_bf16 v[44:47], v[24:27], a[120:123], v[44:47]
    v_mfma_f32_16x16x32_bf16 v[48:51], v[24:27], a[124:127], v[48:51]
    s_barrier
    ds_read_b128 v[24:27], v12 offset:40960
    s_waitcnt lgkmcnt(4)
    v_mfma_f32_16x16x32_bf16 v[52:55], v[28:31], a[120:123], v[52:55]
    v_mfma_f32_16x16x32_bf16 v[56:59], v[28:31], a[124:127], v[56:59]
    ds_read_b128 v[28:31], v12 offset:41984
    s_waitcnt lgkmcnt(4)
    v_mfma_f32_16x16x32_bf16 v[60:63], v[32:35], a[120:123], v[60:63]
    v_mfma_f32_16x16x32_bf16 v[64:67], v[32:35], a[124:127], v[64:67]
    ds_read_b128 v[32:35], v12 offset:43008
    s_waitcnt lgkmcnt(4)
    v_mfma_f32_16x16x32_bf16 v[68:71], v[36:39], a[120:123], v[68:71]
    v_mfma_f32_16x16x32_bf16 v[72:75], v[36:39], a[124:127], v[72:75]
    ds_read_b128 v[36:39], v12 offset:44032
    s_waitcnt lgkmcnt(4)
    v_mfma_f32_16x16x32_bf16 v[76:79], v[40:43], a[120:123], v[76:79]
    v_mfma_f32_16x16x32_bf16 v[80:83], v[40:43], a[124:127], v[80:83]
    ds_read_b128 v[40:43], v12 offset:45056
    s_waitcnt lgkmcnt(4)
    v_mfma_f32_16x16x32_bf16 v[44:47], v[24:27], a[128:131], v[44:47]
    v_mfma_f32_16x16x32_bf16 v[48:51], v[24:27], a[132:135], v[48:51]
    ds_read_b128 v[24:27], v12 offset:51200
    s_waitcnt lgkmcnt(4)
    v_mfma_f32_16x16x32_bf16 v[52:55], v[28:31], a[128:131], v[52:55]
    v_mfma_f32_16x16x32_bf16 v[56:59], v[28:31], a[132:135], v[56:59]
    ds_read_b128 v[28:31], v12 offset:52224
    s_waitcnt lgkmcnt(4)
    v_mfma_f32_16x16x32_bf16 v[60:63], v[32:35], a[128:131], v[60:63]
    v_mfma_f32_16x16x32_bf16 v[64:67], v[32:35], a[132:135], v[64:67]
    ds_read_b128 v[32:35], v12 offset:53248
    ds_read_b64_tr_b16 a[0:1], v6 offset:0
    ds_read_b64_tr_b16 a[2:3], v6 offset:2048
    ds_read_b64_tr_b16 a[4:5], v7 offset:0
    ds_read_b64_tr_b16 a[6:7], v7 offset:2048
    ds_read_b64_tr_b16 a[8:9], v6 offset:8192
    ds_read_b64_tr_b16 a[10:11], v6 offset:10240
    ds_read_b64_tr_b16 a[12:13], v7 offset:8192
    ds_read_b64_tr_b16 a[14:15], v7 offset:10240
    s_waitcnt lgkmcnt(12)
    v_mfma_f32_16x16x32_bf16 v[68:71], v[36:39], a[128:131], v[68:71]
    v_mfma_f32_16x16x32_bf16 v[72:75], v[36:39], a[132:135], v[72:75]
    ds_read_b128 v[36:39], v12 offset:54272
    s_waitcnt lgkmcnt(12)
    v_mfma_f32_16x16x32_bf16 v[76:79], v[40:43], a[128:131], v[76:79]
    v_mfma_f32_16x16x32_bf16 v[80:83], v[40:43], a[132:135], v[80:83]
    ds_read_b128 v[40:43], v12 offset:55296
    s_waitcnt lgkmcnt(12)
    v_mfma_f32_16x16x32_bf16 v[44:47], v[24:27], a[136:139], v[44:47]
    v_mfma_f32_16x16x32_bf16 v[48:51], v[24:27], a[140:143], v[48:51]
    s_barrier
    ds_read_b128 v[24:27], v13 offset:0
    s_waitcnt lgkmcnt(12)
    v_mfma_f32_16x16x32_bf16 v[52:55], v[28:31], a[136:139], v[52:55]
    v_mfma_f32_16x16x32_bf16 v[56:59], v[28:31], a[140:143], v[56:59]
    ds_read_b128 v[28:31], v13 offset:1024
    s_waitcnt lgkmcnt(12)
    v_mfma_f32_16x16x32_bf16 v[60:63], v[32:35], a[136:139], v[60:63]
    v_mfma_f32_16x16x32_bf16 v[64:67], v[32:35], a[140:143], v[64:67]
    ds_read_b128 v[32:35], v13 offset:2048
    s_waitcnt lgkmcnt(4)
    v_mfma_f32_16x16x32_bf16 v[68:71], v[36:39], a[136:139], v[68:71]
    v_mfma_f32_16x16x32_bf16 v[72:75], v[36:39], a[140:143], v[72:75]
    ds_read_b128 v[36:39], v13 offset:3072
    s_waitcnt lgkmcnt(4)
    v_mfma_f32_16x16x32_bf16 v[76:79], v[40:43], a[136:139], v[76:79]
    v_mfma_f32_16x16x32_bf16 v[80:83], v[40:43], a[140:143], v[80:83]
    ds_read_b128 v[40:43], v13 offset:4096
    s_waitcnt lgkmcnt(4)
    v_mfma_f32_16x16x32_bf16 v[44:47], v[24:27], v[96:99], v[44:47]
    v_mfma_f32_16x16x32_bf16 v[48:51], v[24:27], v[100:103], v[48:51]
    ds_read_b128 v[24:27], v13 offset:10240
    s_waitcnt lgkmcnt(4)
    v_mfma_f32_16x16x32_bf16 v[52:55], v[28:31], v[96:99], v[52:55]
    v_mfma_f32_16x16x32_bf16 v[56:59], v[28:31], v[100:103], v[56:59]
    ds_read_b128 v[28:31], v13 offset:11264
    s_waitcnt lgkmcnt(4)
    v_mfma_f32_16x16x32_bf16 v[60:63], v[32:35], v[96:99], v[60:63]
    v_mfma_f32_16x16x32_bf16 v[64:67], v[32:35], v[100:103], v[64:67]
    ds_read_b128 v[32:35], v13 offset:12288
    ds_read_b64_tr_b16 a[16:17], v6 offset:16384
    ds_read_b64_tr_b16 a[18:19], v6 offset:18432
    ds_read_b64_tr_b16 a[20:21], v7 offset:16384
    ds_read_b64_tr_b16 a[22:23], v7 offset:18432
    ds_read_b64_tr_b16 a[24:25], v6 offset:24576
    ds_read_b64_tr_b16 a[26:27], v6 offset:26624
    ds_read_b64_tr_b16 a[28:29], v7 offset:24576
    ds_read_b64_tr_b16 a[30:31], v7 offset:26624
    s_waitcnt lgkmcnt(12)
    v_mfma_f32_16x16x32_bf16 v[68:71], v[36:39], v[96:99], v[68:71]
    v_mfma_f32_16x16x32_bf16 v[72:75], v[36:39], v[100:103], v[72:75]
    ds_read_b128 v[36:39], v13 offset:13312
    s_waitcnt lgkmcnt(12)
    v_mfma_f32_16x16x32_bf16 v[76:79], v[40:43], v[96:99], v[76:79]
    v_mfma_f32_16x16x32_bf16 v[80:83], v[40:43], v[100:103], v[80:83]
    ds_read_b128 v[40:43], v13 offset:14336
    s_waitcnt lgkmcnt(12)
    v_mfma_f32_16x16x32_bf16 v[44:47], v[24:27], v[104:107], v[44:47]
    v_mfma_f32_16x16x32_bf16 v[48:51], v[24:27], v[108:111], v[48:51]
    s_barrier
    ds_read_b128 v[24:27], v13 offset:20480
    s_waitcnt lgkmcnt(12)
    v_mfma_f32_16x16x32_bf16 v[52:55], v[28:31], v[104:107], v[52:55]
    v_mfma_f32_16x16x32_bf16 v[56:59], v[28:31], v[108:111], v[56:59]
    ds_read_b128 v[28:31], v13 offset:21504
    s_waitcnt lgkmcnt(12)
    v_mfma_f32_16x16x32_bf16 v[60:63], v[32:35], v[104:107], v[60:63]
    v_mfma_f32_16x16x32_bf16 v[64:67], v[32:35], v[108:111], v[64:67]
    ds_read_b128 v[32:35], v13 offset:22528
    s_waitcnt lgkmcnt(4)
    v_mfma_f32_16x16x32_bf16 v[68:71], v[36:39], v[104:107], v[68:71]
    v_mfma_f32_16x16x32_bf16 v[72:75], v[36:39], v[108:111], v[72:75]
    ds_read_b128 v[36:39], v13 offset:23552
    s_waitcnt lgkmcnt(4)
    v_mfma_f32_16x16x32_bf16 v[76:79], v[40:43], v[104:107], v[76:79]
    v_mfma_f32_16x16x32_bf16 v[80:83], v[40:43], v[108:111], v[80:83]
    ds_read_b128 v[40:43], v13 offset:24576
    s_waitcnt lgkmcnt(4)
    v_mfma_f32_16x16x32_bf16 v[44:47], v[24:27], a[0:3], v[44:47]
    v_mfma_f32_16x16x32_bf16 v[48:51], v[24:27], a[4:7], v[48:51]
    ds_read_b128 v[24:27], v13 offset:30720
    s_waitcnt lgkmcnt(4)
    v_mfma_f32_16x16x32_bf16 v[52:55], v[28:31], a[0:3], v[52:55]
    v_mfma_f32_16x16x32_bf16 v[56:59], v[28:31], a[4:7], v[56:59]
    ds_read_b128 v[28:31], v13 offset:31744
    s_waitcnt lgkmcnt(4)
    v_mfma_f32_16x16x32_bf16 v[60:63], v[32:35], a[0:3], v[60:63]
    v_mfma_f32_16x16x32_bf16 v[64:67], v[32:35], a[4:7], v[64:67]
    ds_read_b128 v[32:35], v13 offset:32768
    s_waitcnt lgkmcnt(4)
    v_mfma_f32_16x16x32_bf16 v[68:71], v[36:39], a[0:3], v[68:71]
    v_mfma_f32_16x16x32_bf16 v[72:75], v[36:39], a[4:7], v[72:75]
    ds_read_b128 v[36:39], v13 offset:33792
    s_waitcnt lgkmcnt(4)
    v_mfma_f32_16x16x32_bf16 v[76:79], v[40:43], a[0:3], v[76:79]
    v_mfma_f32_16x16x32_bf16 v[80:83], v[40:43], a[4:7], v[80:83]
    ds_read_b128 v[40:43], v13 offset:34816
    s_waitcnt lgkmcnt(4)
    v_mfma_f32_16x16x32_bf16 v[44:47], v[24:27], a[8:11], v[44:47]
    v_mfma_f32_16x16x32_bf16 v[48:51], v[24:27], a[12:15], v[48:51]
    s_barrier
    ds_read_b128 v[24:27], v13 offset:40960
    s_waitcnt lgkmcnt(4)
    v_mfma_f32_16x16x32_bf16 v[52:55], v[28:31], a[8:11], v[52:55]
    v_mfma_f32_16x16x32_bf16 v[56:59], v[28:31], a[12:15], v[56:59]
    ds_read_b128 v[28:31], v13 offset:41984
    s_mul_i32 s3, s52, 5120
    s_add_u32 s3, s3, 32768
    v_lshlrev_b32 v2, 4, v1
    v_add_u32 v6, s3, v2
    s_waitcnt lgkmcnt(4)
    v_mfma_f32_16x16x32_bf16 v[60:63], v[32:35], a[8:11], v[60:63]
    v_mfma_f32_16x16x32_bf16 v[64:67], v[32:35], a[12:15], v[64:67]
    ds_read_b128 v[32:35], v13 offset:43008
    s_xor_b32 s3, s52, 2
    s_mul_i32 s3, s3, 5120
    s_add_u32 s3, s3, 32768
    v_add_u32 v7, s3, v2
    s_waitcnt lgkmcnt(4)
    v_mfma_f32_16x16x32_bf16 v[68:71], v[36:39], a[8:11], v[68:71]
    v_mfma_f32_16x16x32_bf16 v[72:75], v[36:39], a[12:15], v[72:75]
    ds_read_b128 v[36:39], v13 offset:44032
    v_lshlrev_b32 v3, 3, v1
    s_waitcnt lgkmcnt(4)
    v_mfma_f32_16x16x32_bf16 v[76:79], v[40:43], a[8:11], v[76:79]
    v_mfma_f32_16x16x32_bf16 v[80:83], v[40:43], a[12:15], v[80:83]
    ds_read_b128 v[40:43], v13 offset:45056
    s_waitcnt lgkmcnt(4)
    v_mfma_f32_16x16x32_bf16 v[44:47], v[24:27], a[16:19], v[44:47]
    v_mfma_f32_16x16x32_bf16 v[48:51], v[24:27], a[20:23], v[48:51]
    ds_read_b128 v[24:27], v13 offset:51200
    s_waitcnt lgkmcnt(4)
    v_mfma_f32_16x16x32_bf16 v[52:55], v[28:31], a[16:19], v[52:55]
    v_mfma_f32_16x16x32_bf16 v[56:59], v[28:31], a[20:23], v[56:59]
    ds_read_b128 v[28:31], v13 offset:52224
    s_waitcnt lgkmcnt(4)
    v_mfma_f32_16x16x32_bf16 v[60:63], v[32:35], a[16:19], v[60:63]
    v_mfma_f32_16x16x32_bf16 v[64:67], v[32:35], a[20:23], v[64:67]
    ds_read_b128 v[32:35], v13 offset:53248
    s_waitcnt lgkmcnt(4)
    v_mfma_f32_16x16x32_bf16 v[68:71], v[36:39], a[16:19], v[68:71]
    v_mfma_f32_16x16x32_bf16 v[72:75], v[36:39], a[20:23], v[72:75]
    ds_read_b128 v[36:39], v13 offset:54272
    s_waitcnt lgkmcnt(4)
    v_mfma_f32_16x16x32_bf16 v[76:79], v[40:43], a[16:19], v[76:79]
    v_mfma_f32_16x16x32_bf16 v[80:83], v[40:43], a[20:23], v[80:83]
    ds_read_b128 v[40:43], v13 offset:55296
    s_waitcnt lgkmcnt(4)
    v_mfma_f32_16x16x32_bf16 v[48:51], v[24:27], a[28:31], v[48:51]
    s_waitcnt lgkmcnt(3)
    v_mfma_f32_16x16x32_bf16 v[56:59], v[28:31], a[28:31], v[56:59]
    s_waitcnt lgkmcnt(2)
    v_mfma_f32_16x16x32_bf16 v[64:67], v[32:35], a[28:31], v[64:67]
    s_waitcnt lgkmcnt(1)
    v_mfma_f32_16x16x32_bf16 v[72:75], v[36:39], a[28:31], v[72:75]
    s_waitcnt lgkmcnt(0)
    v_mfma_f32_16x16x32_bf16 v[80:83], v[40:43], a[28:31], v[80:83]
    v_mfma_f32_16x16x32_bf16 v[44:47], v[24:27], a[24:27], v[44:47]
    v_mfma_f32_16x16x32_bf16 v[52:55], v[28:31], a[24:27], v[52:55]
    v_mfma_f32_16x16x32_bf16 v[60:63], v[32:35], a[24:27], v[60:63]
    v_mfma_f32_16x16x32_bf16 v[68:71], v[36:39], a[24:27], v[68:71]
    ds_write_b128 v6, v[48:51] offset:0
    v_mfma_f32_16x16x32_bf16 v[76:79], v[40:43], a[24:27], v[76:79]
    ds_write_b128 v6, v[56:59] offset:1024
    ds_write_b128 v6, v[64:67] offset:2048
    ds_write_b128 v6, v[72:75] offset:3072
    ds_write_b128 v6, v[80:83] offset:4096
    s_lshl_b32 s3, s57, 2
    s_lshl_b32 s23, s23, 1
    s_add_u32 s3, s3, s23
    s_add_u32 s3, s3, s22
    s_mul_i32 s3, s3, 20480
    s_lshl_b32 s58, s56, 11
    s_add_u32 s58, s58, s3
    s_lshr_b32 s59, s56, 1
    s_add_u32 s59, s59, 16
    s_lshl_b32 s59, s59, 10
    s_add_u32 s59, s59, s3
    s_and_b32 s3, s56, 1
    s_lshl_b32 s3, s3, 9
    s_add_u32 s59, s59, s3
    s_waitcnt  lgkmcnt(0)
    s_barrier
    ds_read_b128 v[24:27], v7 offset:0
    ds_read_b128 v[28:31], v7 offset:1024
    ds_read_b128 v[32:35], v7 offset:2048
    ds_read_b128 v[36:39], v7 offset:3072
    ds_read_b128 v[40:43], v7 offset:4096
    s_waitcnt lgkmcnt(4)
    v_add_f32 v44, v44, v24
    v_add_f32 v45, v45, v25
    v_add_f32 v46, v46, v26
    v_add_f32 v47, v47, v27
    v_cvt_pk_bf16_f32 v84, v44, v45
    v_cvt_pk_bf16_f32 v85, v46, v47
    s_waitcnt lgkmcnt(3)
    v_add_f32 v52, v52, v28
    v_add_f32 v53, v53, v29
    v_add_f32 v54, v54, v30
    v_add_f32 v55, v55, v31
    v_cvt_pk_bf16_f32 v86, v52, v53
    v_cvt_pk_bf16_f32 v87, v54, v55
    buffer_store_dwordx4 v[84:87], v2, s[40:43], s58 offen sc1
    s_waitcnt lgkmcnt(2)
    v_add_f32 v60, v60, v32
    v_add_f32 v61, v61, v33
    v_add_f32 v62, v62, v34
    v_add_f32 v63, v63, v35
    v_cvt_pk_bf16_f32 v88, v60, v61
    v_cvt_pk_bf16_f32 v89, v62, v63
    s_waitcnt lgkmcnt(1)
    v_add_f32 v68, v68, v36
    v_add_f32 v69, v69, v37
    v_add_f32 v70, v70, v38
    v_add_f32 v71, v71, v39
    v_cvt_pk_bf16_f32 v90, v68, v69
    v_cvt_pk_bf16_f32 v91, v70, v71
    buffer_store_dwordx4 v[88:91], v2, s[40:43], s58 offen offset:1024 sc1
    s_waitcnt lgkmcnt(0)
    v_add_f32 v76, v76, v40
    v_add_f32 v77, v77, v41
    v_add_f32 v78, v78, v42
    v_add_f32 v79, v79, v43
    v_cvt_pk_bf16_f32 v92, v76, v77
    v_cvt_pk_bf16_f32 v93, v78, v79
    buffer_store_dwordx2 v[92:93], v3, s[40:43], s59 offen sc1
    s_branch L_p2_c
L_xr_c:
    s_and_b32 s23, s52, 1
    s_lshr_b32 s22, s52, 1
    s_mul_i32 s3, s23, 160
    v_and_b32 v2, 3, v1
    v_lshrrev_b32 v3, 2, v4
    v_lshl_add_u32 v3, v5, 3, v3
    v_mul_u32_u24 v3, 320, v3
    v_add_u32 v3, 16384, v3
    v_and_b32 v21, 1, v5
    v_lshlrev_b32 v21, 5, v21
    v_lshlrev_b32 v2, 3, v2
    v_add_u32 v2, s3, v2
    v_add_u32 v16, 0, v2
    v_xor_b32 v16, v16, v21
    v_add_u32 v6, v16, v3
    v_add_u32 v16, 32, v2
    v_xor_b32 v16, v16, v21
    v_add_u32 v7, v16, v3
    v_add_u32 v16, 64, v2
    v_xor_b32 v16, v16, v21
    v_add_u32 v8, v16, v3
    v_add_u32 v16, 96, v2
    v_xor_b32 v16, v16, v21
    v_add_u32 v9, v16, v3
    v_add_u32 v16, 128, v2
    v_xor_b32 v16, v16, v21
    v_add_u32 v10, v16, v3
    v_lshrrev_b32 v2, 1, v4
    v_xor_b32 v2, v2, v5
    v_lshlrev_b32 v2, 4, v2
    v_lshl_add_u32 v2, v4, 7, v2
    s_lshl_b32 s3, s22, 13
    v_add_u32 v11, s3, v2
    v_xor_b32 v12, 64, v11
    s_mov_b32 s58, 0
    s_mov_b32 s59, 0
    v_mov_b32 v24, 0
    v_mov_b32 v25, 0
    v_mov_b32 v26, 0
    v_mov_b32 v27, 0
    v_mov_b32 v28, 0
    v_mov_b32 v29, 0
    v_mov_b32 v30, 0
    v_mov_b32 v31, 0
    v_mov_b32 v32, 0
    v_mov_b32 v33, 0
    v_mov_b32 v34, 0
    v_mov_b32 v35, 0
    v_mov_b32 v36, 0
    v_mov_b32 v37, 0
    v_mov_b32 v38, 0
    v_mov_b32 v39, 0
    v_mov_b32 v40, 0
    v_mov_b32 v41, 0
    v_mov_b32 v42, 0
    v_mov_b32 v43, 0
    v_mov_b32 v44, 0
    v_mov_b32 v45, 0
    v_mov_b32 v46, 0
    v_mov_b32 v47, 0
    v_mov_b32 v48, 0
    v_mov_b32 v49, 0
    v_mov_b32 v50, 0
    v_mov_b32 v51, 0
    v_mov_b32 v52, 0
    v_mov_b32 v53, 0
    v_mov_b32 v54, 0
    v_mov_b32 v55, 0
    v_mov_b32 v56, 0
    v_mov_b32 v57, 0
    v_mov_b32 v58, 0
    v_mov_b32 v59, 0
    v_mov_b32 v60, 0
    v_mov_b32 v61, 0
    v_mov_b32 v62, 0
    v_mov_b32 v63, 0
    v_mov_b32 v64, 0
    v_mov_b32 v65, 0
    v_mov_b32 v66, 0
    v_mov_b32 v67, 0
    v_mov_b32 v68, 0
    v_mov_b32 v69, 0
    v_mov_b32 v70, 0
    v_mov_b32 v71, 0
    v_mov_b32 v72, 0
    v_mov_b32 v73, 0
    v_mov_b32 v74, 0
    v_mov_b32 v75, 0
    v_mov_b32 v76, 0
    v_mov_b32 v77, 0
    v_mov_b32 v78, 0
    v_mov_b32 v79, 0
    v_mov_b32 v80, 0
    v_mov_b32 v81, 0
    v_mov_b32 v82, 0
    v_mov_b32 v83, 0
    v_mov_b32 v84, 0
    v_mov_b32 v85, 0
    v_mov_b32 v86, 0
    v_mov_b32 v87, 0
    v_mov_b32 v88, 0
    v_mov_b32 v89, 0
    v_mov_b32 v90, 0
    v_mov_b32 v91, 0
    v_mov_b32 v92, 0
    v_mov_b32 v93, 0
    v_mov_b32 v94, 0
    v_mov_b32 v95, 0
    v_mov_b32 v96, 0
    v_mov_b32 v97, 0
    v_mov_b32 v98, 0
    v_mov_b32 v99, 0
    v_mov_b32 v100, 0
    v_mov_b32 v101, 0
    v_mov_b32 v102, 0
    v_mov_b32 v103, 0
    s_waitcnt lgkmcnt(0)
    s_mov_b32 s48, s18
    s_mov_b32 s49, s19
    s_mov_b32 s50, 256
    s_mov_b32 s51, 0x20000
    s_mov_b32 s40, s20
    s_mov_b32 s41, s21
    s_mov_b32 s42, 7340032
    s_mov_b32 s43, 0x20000
    s_barrier
    v_add_u32 v13, s58, v6
    v_add_u32 v14, s58, v7
    v_add_u32 v15, s58, v8
    v_add_u32 v104, s58, v9
    v_add_u32 v105, s58, v10
    v_add_u32 v106, s58, v11
    v_add_u32 v107, s58, v12
    s_add_u32 s58, s58, 36864
    s_cmp_eq_u32 s58, 147456
    s_cselect_b32 s58, 0, s58
    v_mov_b32 v21, 0
    buffer_load_dword v20, v21, s[48:51], 0 offen sc1
    ds_read_b64_tr_b16 a[0:1], v13 offset:0
    ds_read_b64_tr_b16 a[2:3], v13 offset:1280
    ds_read_b128 a[20:23], v106 offset:0
    ds_read_b64_tr_b16 a[4:5], v14 offset:0
    ds_read_b64_tr_b16 a[6:7], v14 offset:1280
    ds_read_b128 a[24:27], v106 offset:2048
    ds_read_b64_tr_b16 a[8:9], v15 offset:0
    ds_read_b64_tr_b16 a[10:11], v15 offset:1280
    ds_read_b128 a[28:31], v106 offset:4096
    ds_read_b64_tr_b16 a[12:13], v104 offset:0
    ds_read_b64_tr_b16 a[14:15], v104 offset:1280
    ds_read_b128 a[32:35], v106 offset:6144
    ds_read_b64_tr_b16 a[16:17], v105 offset:0
    ds_read_b64_tr_b16 a[18:19], v105 offset:1280
    s_waitcnt  lgkmcnt(0)
L_xloop:
    v_mfma_f32_16x16x32_bf16 v[24:27], a[0:3], a[20:23], v[24:27]
    v_mfma_f32_16x16x32_bf16 v[28:31], a[0:3], a[24:27], v[28:31]
    ds_read_b64_tr_b16 a[36:37], v13 offset:10240
    v_mfma_f32_16x16x32_bf16 v[40:43], a[4:7], a[20:23], v[40:43]
    ds_read_b64_tr_b16 a[38:39], v13 offset:11520
    v_mfma_f32_16x16x32_bf16 v[44:47], a[4:7], a[24:27], v[44:47]
    ds_read_b128 a[56:59], v107 offset:0
    v_mfma_f32_16x16x32_bf16 v[32:35], a[0:3], a[28:31], v[32:35]
    ds_read_b64_tr_b16 a[40:41], v14 offset:10240
    v_mfma_f32_16x16x32_bf16 v[48:51], a[4:7], a[28:31], v[48:51]
    ds_read_b64_tr_b16 a[42:43], v14 offset:11520
    v_mfma_f32_16x16x32_bf16 v[56:59], a[8:11], a[20:23], v[56:59]
    ds_read_b128 a[60:63], v107 offset:2048
    v_mfma_f32_16x16x32_bf16 v[60:63], a[8:11], a[24:27], v[60:63]
    ds_read_b64_tr_b16 a[44:45], v15 offset:10240
    v_mfma_f32_16x16x32_bf16 v[64:67], a[8:11], a[28:31], v[64:67]
    ds_read_b64_tr_b16 a[46:47], v15 offset:11520
    v_mfma_f32_16x16x32_bf16 v[36:39], a[0:3], a[32:35], v[36:39]
    ds_read_b128 a[64:67], v107 offset:4096
    v_mfma_f32_16x16x32_bf16 v[52:55], a[4:7], a[32:35], v[52:55]
    ds_read_b64_tr_b16 a[48:49], v104 offset:10240
    v_mfma_f32_16x16x32_bf16 v[68:71], a[8:11], a[32:35], v[68:71]
    ds_read_b64_tr_b16 a[50:51], v104 offset:11520
    v_mfma_f32_16x16x32_bf16 v[72:75], a[12:15], a[20:23], v[72:75]
    ds_read_b128 a[68:71], v107 offset:6144
    v_mfma_f32_16x16x32_bf16 v[76:79], a[12:15], a[24:27], v[76:79]
    ds_read_b64_tr_b16 a[52:53], v105 offset:10240
    v_mfma_f32_16x16x32_bf16 v[80:83], a[12:15], a[28:31], v[80:83]
    ds_read_b64_tr_b16 a[54:55], v105 offset:11520
    v_mfma_f32_16x16x32_bf16 v[84:87], a[12:15], a[32:35], v[84:87]
    v_mfma_f32_16x16x32_bf16 v[88:91], a[16:19], a[20:23], v[88:91]
    v_mfma_f32_16x16x32_bf16 v[92:95], a[16:19], a[24:27], v[92:95]
    v_mfma_f32_16x16x32_bf16 v[96:99], a[16:19], a[28:31], v[96:99]
    v_mfma_f32_16x16x32_bf16 v[100:103], a[16:19], a[32:35], v[100:103]
    s_waitcnt lgkmcnt(11)
    v_mfma_f32_16x16x32_bf16 v[24:27], a[36:39], a[56:59], v[24:27]
    s_barrier
    v_add_u32 v13, s58, v6
    v_add_u32 v14, s58, v7
    v_add_u32 v15, s58, v8
    v_add_u32 v104, s58, v9
    v_add_u32 v105, s58, v10
    v_add_u32 v106, s58, v11
    v_add_u32 v107, s58, v12
    s_add_u32 s58, s58, 36864
    s_cmp_eq_u32 s58, 147456
    s_cselect_b32 s58, 0, s58
    s_waitcnt lgkmcnt(8)
    v_mfma_f32_16x16x32_bf16 v[28:31], a[36:39], a[60:63], v[28:31]
    ds_read_b64_tr_b16 a[0:1], v13 offset:0
    v_mfma_f32_16x16x32_bf16 v[40:43], a[40:43], a[56:59], v[40:43]
    ds_read_b64_tr_b16 a[2:3], v13 offset:1280
    v_mfma_f32_16x16x32_bf16 v[44:47], a[40:43], a[60:63], v[44:47]
    ds_read_b128 a[20:23], v106 offset:0
    s_waitcnt lgkmcnt(8)
    v_mfma_f32_16x16x32_bf16 v[32:35], a[36:39], a[64:67], v[32:35]
    ds_read_b64_tr_b16 a[4:5], v14 offset:0
    v_mfma_f32_16x16x32_bf16 v[48:51], a[40:43], a[64:67], v[48:51]
    ds_read_b64_tr_b16 a[6:7], v14 offset:1280
    v_mfma_f32_16x16x32_bf16 v[56:59], a[44:47], a[56:59], v[56:59]
    ds_read_b128 a[24:27], v106 offset:2048
    v_mfma_f32_16x16x32_bf16 v[60:63], a[44:47], a[60:63], v[60:63]
    ds_read_b64_tr_b16 a[8:9], v15 offset:0
    v_mfma_f32_16x16x32_bf16 v[64:67], a[44:47], a[64:67], v[64:67]
    ds_read_b64_tr_b16 a[10:11], v15 offset:1280
    s_waitcnt lgkmcnt(10)
    v_mfma_f32_16x16x32_bf16 v[36:39], a[36:39], a[68:71], v[36:39]
    ds_read_b128 a[28:31], v106 offset:4096
    v_mfma_f32_16x16x32_bf16 v[52:55], a[40:43], a[68:71], v[52:55]
    ds_read_b64_tr_b16 a[12:13], v104 offset:0
    v_mfma_f32_16x16x32_bf16 v[68:71], a[44:47], a[68:71], v[68:71]
    ds_read_b64_tr_b16 a[14:15], v104 offset:1280
    v_mfma_f32_16x16x32_bf16 v[72:75], a[48:51], a[56:59], v[72:75]
    ds_read_b128 a[32:35], v106 offset:6144
    v_mfma_f32_16x16x32_bf16 v[76:79], a[48:51], a[60:63], v[76:79]
    ds_read_b64_tr_b16 a[16:17], v105 offset:0
    v_mfma_f32_16x16x32_bf16 v[80:83], a[48:51], a[64:67], v[80:83]
    ds_read_b64_tr_b16 a[18:19], v105 offset:1280
    v_mfma_f32_16x16x32_bf16 v[84:87], a[48:51], a[68:71], v[84:87]
    s_waitcnt lgkmcnt(14)
    v_mfma_f32_16x16x32_bf16 v[88:91], a[52:55], a[56:59], v[88:91]
    v_mfma_f32_16x16x32_bf16 v[92:95], a[52:55], a[60:63], v[92:95]
    v_mfma_f32_16x16x32_bf16 v[96:99], a[52:55], a[64:67], v[96:99]
    v_mfma_f32_16x16x32_bf16 v[100:103], a[52:55], a[68:71], v[100:103]
    s_add_u32 s59, s59, 1
    s_cmp_lt_u32 s59, 10
    s_waitcnt  lgkmcnt(0)
    s_cbranch_scc1 L_xloop
    s_lshl_b32 s3, s57, 1
    s_add_u32 s3, s3, s22
    s_mul_i32 s3, s3, 81920
    s_add_u32 s3, s3, 2097152
    s_lshl_b32 s58, s56, 1
    s_add_u32 s58, s58, s23
    s_lshl_b32 s58, s58, 11
    s_add_u32 s58, s58, s3
    s_add_u32 s59, s56, 16
    s_lshl_b32 s59, s59, 10
    s_add_u32 s59, s59, s3
    s_lshl_b32 s3, s23, 9
    s_add_u32 s59, s59, s3
    v_lshlrev_b32 v2, 4, v1
    v_lshlrev_b32 v3, 3, v1
    v_cvt_pk_bf16_f32 v6, v24, v25
    v_cvt_pk_bf16_f32 v7, v26, v27
    v_cvt_pk_bf16_f32 v8, v40, v41
    v_cvt_pk_bf16_f32 v9, v42, v43
    v_cvt_pk_bf16_f32 v10, v56, v57
    v_cvt_pk_bf16_f32 v11, v58, v59
    v_cvt_pk_bf16_f32 v12, v72, v73
    v_cvt_pk_bf16_f32 v13, v74, v75
    v_cvt_pk_bf16_f32 v14, v88, v89
    v_cvt_pk_bf16_f32 v15, v90, v91
    buffer_store_dwordx4 v[6:9], v2, s[40:43], s58 offen sc1
    buffer_store_dwordx4 v[10:13], v2, s[40:43], s58 offen offset:1024 sc1
    buffer_store_dwordx2 v[14:15], v3, s[40:43], s59 offen sc1
    s_add_u32 s58, s58, 20480
    s_add_u32 s59, s59, 20480
    v_cvt_pk_bf16_f32 v104, v28, v29
    v_cvt_pk_bf16_f32 v105, v30, v31
    v_cvt_pk_bf16_f32 v106, v44, v45
    v_cvt_pk_bf16_f32 v107, v46, v47
    v_cvt_pk_bf16_f32 v108, v60, v61
    v_cvt_pk_bf16_f32 v109, v62, v63
    v_cvt_pk_bf16_f32 v110, v76, v77
    v_cvt_pk_bf16_f32 v111, v78, v79
    v_cvt_pk_bf16_f32 v18, v92, v93
    v_cvt_pk_bf16_f32 v19, v94, v95
    buffer_store_dwordx4 v[104:107], v2, s[40:43], s58 offen sc1
    buffer_store_dwordx4 v[108:111], v2, s[40:43], s58 offen offset:1024 sc1
    buffer_store_dwordx2 v[18:19], v3, s[40:43], s59 offen sc1
    s_add_u32 s58, s58, 20480
    s_add_u32 s59, s59, 20480
    v_cvt_pk_bf16_f32 v24, v32, v33
    v_cvt_pk_bf16_f32 v25, v34, v35
    v_cvt_pk_bf16_f32 v26, v48, v49
    v_cvt_pk_bf16_f32 v27, v50, v51
    v_cvt_pk_bf16_f32 v40, v64, v65
    v_cvt_pk_bf16_f32 v41, v66, v67
    v_cvt_pk_bf16_f32 v42, v80, v81
    v_cvt_pk_bf16_f32 v43, v82, v83
    v_cvt_pk_bf16_f32 v56, v96, v97
    v_cvt_pk_bf16_f32 v57, v98, v99
    buffer_store_dwordx4 v[24:27], v2, s[40:43], s58 offen sc1
    buffer_store_dwordx4 v[40:43], v2, s[40:43], s58 offen offset:1024 sc1
    buffer_store_dwordx2 v[56:57], v3, s[40:43], s59 offen sc1
    s_add_u32 s58, s58, 20480
    s_add_u32 s59, s59, 20480
    v_cvt_pk_bf16_f32 v28, v36, v37
    v_cvt_pk_bf16_f32 v29, v38, v39
    v_cvt_pk_bf16_f32 v30, v52, v53
    v_cvt_pk_bf16_f32 v31, v54, v55
    v_cvt_pk_bf16_f32 v44, v68, v69
    v_cvt_pk_bf16_f32 v45, v70, v71
    v_cvt_pk_bf16_f32 v46, v84, v85
    v_cvt_pk_bf16_f32 v47, v86, v87
    v_cvt_pk_bf16_f32 v60, v100, v101
    v_cvt_pk_bf16_f32 v61, v102, v103
    buffer_store_dwordx4 v[28:31], v2, s[40:43], s58 offen sc1
    buffer_store_dwordx4 v[44:47], v2, s[40:43], s58 offen offset:1024 sc1
    buffer_store_dwordx2 v[60:61], v3, s[40:43], s59 offen sc1
L_p2_c:
    s_lshl_b32 s3, s93, 2
    s_add_u32 s3, s3, s52
    s_mul_i32 s22, s3, 40960
    s_add_u32 s22, s22, 2097152
    s_add_u32 s23, s22, 20480
    s_mul_i32 s61, s3, 98304
    s_mul_i32 s3, s94, 192
    s_add_u32 s61, s61, s3
    s_add_u32 s62, s61, 49152
    s_mov_b32 s63, s95
    s_lshl_b32 s3, s93, 10
    s_add_u32 s3, s3, 6881280
    v_and_b32 v22, 3, v1
    v_lshlrev_b32 v22, 8, v22
    v_add_u32 v22, s3, v22
    s_waitcnt vmcnt(0)
    s_barrier
    buffer_load_dword v16, v22, s[40:43], 0 offen sc1
    s_mov_b32 s91, 0
Lnon_3:
    v_readfirstlane_b32 s90, v20
    s_add_u32 s91, s91, 1
    s_cmp_lg_u32 s90, 0
    s_cbranch_scc1 Lnon_4
    s_cmp_gt_u32 s91, 0x100000
    s_cbranch_scc1 L_end
    buffer_load_dword v20, v21, s[48:51], 0 offen sc1
    s_waitcnt vmcnt(0)
    s_branch Lnon_3
Lnon_4:
    s_mov_b32 s91, 0
    s_waitcnt vmcnt(0)
Lp_5:
    v_cmp_ne_u32 vcc, s90, v16
    s_add_u32 s91, s91, 1
    s_cmp_gt_u32 s91, 0x100000
    s_cbranch_scc1 L_end
    s_nop 2
    s_cbranch_vccz Lp_6
    buffer_load_dword v16, v22, s[40:43], 0 offen sc1
    s_waitcnt vmcnt(0)
    s_branch Lp_5
Lp_6:
    s_add_u32 s58, s22, s63
    s_add_u32 s59, s23, s63
    s_add_u32 s63, s63, 2048
    s_and_b32 s63, s63, 0x3fff
    buffer_load_dwordx4 a[0:3], v2, s[40:43], s58 offen offset:0 sc1
    buffer_load_dwordx4 a[80:83], v2, s[40:43], s59 offen offset:0 sc1
    buffer_load_dwordx4 a[4:7], v2, s[40:43], s58 offen offset:1024 sc1
    buffer_load_dwordx4 a[84:87], v2, s[40:43], s59 offen offset:1024 sc1
    s_add_u32 s58, s22, s63
    s_add_u32 s59, s23, s63
    s_add_u32 s63, s63, 2048
    s_and_b32 s63, s63, 0x3fff
    buffer_load_dwordx4 a[8:11], v2, s[40:43], s58 offen offset:0 sc1
    buffer_load_dwordx4 a[88:91], v2, s[40:43], s59 offen offset:0 sc1
    buffer_load_dwordx4 a[12:15], v2, s[40:43], s58 offen offset:1024 sc1
    buffer_load_dwordx4 a[92:95], v2, s[40:43], s59 offen offset:1024 sc1
    s_add_u32 s58, s22, s63
    s_add_u32 s59, s23, s63
    s_add_u32 s63, s63, 2048
    s_and_b32 s63, s63, 0x3fff
    buffer_load_dwordx4 a[16:19], v2, s[40:43], s58 offen offset:0 sc1
    buffer_load_dwordx4 a[96:99], v2, s[40:43], s59 offen offset:0 sc1
    buffer_load_dwordx4 a[20:23], v2, s[40:43], s58 offen offset:1024 sc1
    buffer_load_dwordx4 a[100:103], v2, s[40:43], s59 offen offset:1024 sc1
    s_mov_b32 s44, s16
    s_mov_b32 s45, s17
    s_mov_b32 s46, 6291456
    s_mov_b32 s47, 0x20000
    v_add_u32 v8, 0x10000, v2
    v_add_u32 v7, 0x10000, v3
    s_mul_i32 s3, s52, 6656
    s_add_u32 s3, s3, 122880
    v_mul_u32_u24 v9, 208, v4
    v_lshl_add_u32 v9, v5, 3, v9
    v_add_u32 v9, s3, v9
    s_mov_b32 s60, 3072
    v_add_u32 v16, 0, v1
    v_mul_u32_u24 v17, 5462, v16
    v_lshrrev_b32 v17, 16, v17
    v_mul_u32_u24 v18, 12, v17
    v_sub_u32 v18, v16, v18
    v_lshlrev_b32 v18, 4, v18
    v_mad_u32_u24 v13, v17, s60, v18
    v_mul_u32_u24 v17, 208, v17
    v_add3_u32 v10, v17, v18, s3
    v_add_u32 v16, 64, v1
    v_mul_u32_u24 v17, 5462, v16
    v_lshrrev_b32 v17, 16, v17
    v_mul_u32_u24 v18, 12, v17
    v_sub_u32 v18, v16, v18
    v_lshlrev_b32 v18, 4, v18
    v_mad_u32_u24 v14, v17, s60, v18
    v_mul_u32_u24 v17, 208, v17
    v_add3_u32 v11, v17, v18, s3
    v_add_u32 v16, 128, v1
    v_mul_u32_u24 v17, 5462, v16
    v_lshrrev_b32 v17, 16, v17
    v_mul_u32_u24 v18, 12, v17
    v_sub_u32 v18, v16, v18
    v_lshlrev_b32 v18, 4, v18
    v_mad_u32_u24 v15, v17, s60, v18
    v_mul_u32_u24 v17, 208, v17
    v_add3_u32 v12, v17, v18, s3
    s_barrier
    ds_read_b128 v[24:27], v2 offset:0
    ds_read_b128 v[28:31], v2 offset:1024
    ds_read_b128 v[32:35], v2 offset:2048
    ds_read_b128 v[36:39], v2 offset:3072
    ds_read_b128 v[40:43], v2 offset:4096
    ds_read_b128 v[44:47], v2 offset:5120
    s_waitcnt vmcnt(8)
    s_waitcnt lgkmcnt(5)
    v_mfma_f32_16x16x32_bf16 v[48:51], v[24:27], a[0:3], 0
    v_mfma_f32_16x16x32_bf16 v[52:55], v[24:27], a[80:83], 0
    ds_read_b128 v[24:27], v2 offset:6144
    s_waitcnt lgkmcnt(5)
    v_mfma_f32_16x16x32_bf16 v[56:59], v[28:31], a[0:3], 0
    v_mfma_f32_16x16x32_bf16 v[60:63], v[28:31], a[80:83], 0
    ds_read_b128 v[28:31], v2 offset:7168
    s_add_u32 s58, s22, s63
    s_add_u32 s59, s23, s63
    s_add_u32 s63, s63, 2048
    s_and_b32 s63, s63, 0x3fff
    buffer_load_dwordx4 a[24:27], v2, s[40:43], s58 offen offset:0 sc1
    s_waitcnt lgkmcnt(5)
    v_mfma_f32_16x16x32_bf16 v[64:67], v[32:35], a[0:3], 0
    v_mfma_f32_16x16x32_bf16 v[68:71], v[32:35], a[80:83], 0
    ds_read_b128 v[32:35], v2 offset:8192
    s_waitcnt lgkmcnt(5)
    v_mfma_f32_16x16x32_bf16 v[72:75], v[36:39], a[0:3], 0
    v_mfma_f32_16x16x32_bf16 v[76:79], v[36:39], a[80:83], 0
    ds_read_b128 v[36:39], v2 offset:9216
    buffer_load_dwordx4 a[104:107], v2, s[40:43], s59 offen offset:0 sc1
    s_waitcnt lgkmcnt(5)
    v_mfma_f32_16x16x32_bf16 v[80:83], v[40:43], a[0:3], 0
    v_mfma_f32_16x16x32_bf16 v[84:87], v[40:43], a[80:83], 0
    ds_read_b128 v[40:43], v2 offset:10240
    s_waitcnt lgkmcnt(5)
    v_mfma_f32_16x16x32_bf16 v[88:91], v[44:47], a[0:3], 0
    v_mfma_f32_16x16x32_bf16 v[92:95], v[44:47], a[80:83], 0
    ds_read_b128 v[44:47], v2 offset:11264
    s_waitcnt lgkmcnt(5)
    v_mfma_f32_16x16x32_bf16 v[48:51], v[24:27], a[4:7], v[48:51]
    v_mfma_f32_16x16x32_bf16 v[52:55], v[24:27], a[84:87], v[52:55]
    s_barrier
    ds_read_b128 v[24:27], v2 offset:12288
    s_waitcnt lgkmcnt(5)
    v_mfma_f32_16x16x32_bf16 v[56:59], v[28:31], a[4:7], v[56:59]
    v_mfma_f32_16x16x32_bf16 v[60:63], v[28:31], a[84:87], v[60:63]
    ds_read_b128 v[28:31], v2 offset:13312
    buffer_load_dwordx4 a[28:31], v2, s[40:43], s58 offen offset:1024 sc1
    s_waitcnt lgkmcnt(5)
    v_mfma_f32_16x16x32_bf16 v[64:67], v[32:35], a[4:7], v[64:67]
    v_mfma_f32_16x16x32_bf16 v[68:71], v[32:35], a[84:87], v[68:71]
    ds_read_b128 v[32:35], v2 offset:14336
    s_waitcnt lgkmcnt(5)
    v_mfma_f32_16x16x32_bf16 v[72:75], v[36:39], a[4:7], v[72:75]
    v_mfma_f32_16x16x32_bf16 v[76:79], v[36:39], a[84:87], v[76:79]
    ds_read_b128 v[36:39], v2 offset:15360
    buffer_load_dwordx4 a[108:111], v2, s[40:43], s59 offen offset:1024 sc1
    s_waitcnt lgkmcnt(5)
    v_mfma_f32_16x16x32_bf16 v[80:83], v[40:43], a[4:7], v[80:83]
    v_mfma_f32_16x16x32_bf16 v[84:87], v[40:43], a[84:87], v[84:87]
    ds_read_b128 v[40:43], v2 offset:16384
    s_waitcnt lgkmcnt(5)
    v_mfma_f32_16x16x32_bf16 v[88:91], v[44:47], a[4:7], v[88:91]
    v_mfma_f32_16x16x32_bf16 v[92:95], v[44:47], a[84:87], v[92:95]
    ds_read_b128 v[44:47], v2 offset:17408
    s_waitcnt vmcnt(8)
    s_waitcnt lgkmcnt(5)
    v_mfma_f32_16x16x32_bf16 v[48:51], v[24:27], a[8:11], v[48:51]
    v_mfma_f32_16x16x32_bf16 v[52:55], v[24:27], a[88:91], v[52:55]
    ds_read_b128 v[24:27], v2 offset:18432
    s_waitcnt lgkmcnt(5)
    v_mfma_f32_16x16x32_bf16 v[56:59], v[28:31], a[8:11], v[56:59]
    v_mfma_f32_16x16x32_bf16 v[60:63], v[28:31], a[88:91], v[60:63]
    ds_read_b128 v[28:31], v2 offset:19456
    s_add_u32 s58, s22, s63
    s_add_u32 s59, s23, s63
    s_add_u32 s63, s63, 2048
    s_and_b32 s63, s63, 0x3fff
    buffer_load_dwordx4 a[32:35], v2, s[40:43], s58 offen offset:0 sc1
    s_waitcnt lgkmcnt(5)
    v_mfma_f32_16x16x32_bf16 v[64:67], v[32:35], a[8:11], v[64:67]
    v_mfma_f32_16x16x32_bf16 v[68:71], v[32:35], a[88:91], v[68:71]
    ds_read_b128 v[32:35], v2 offset:20480
    s_waitcnt lgkmcnt(5)
    v_mfma_f32_16x16x32_bf16 v[72:75], v[36:39], a[8:11], v[72:75]
    v_mfma_f32_16x16x32_bf16 v[76:79], v[36:39], a[88:91], v[76:79]
    ds_read_b128 v[36:39], v2 offset:21504
    buffer_load_dwordx4 a[112:115], v2, s[40:43], s59 offen offset:0 sc1
    s_waitcnt lgkmcnt(5)
    v_mfma_f32_16x16x32_bf16 v[80:83], v[40:43], a[8:11], v[80:83]
    v_mfma_f32_16x16x32_bf16 v[84:87], v[40:43], a[88:91], v[84:87]
    ds_read_b128 v[40:43], v2 offset:22528
    s_waitcnt lgkmcnt(5)
    v_mfma_f32_16x16x32_bf16 v[88:91], v[44:47], a[8:11], v[88:91]
    v_mfma_f32_16x16x32_bf16 v[92:95], v[44:47], a[88:91], v[92:95]
    ds_read_b128 v[44:47], v2 offset:23552
    s_waitcnt lgkmcnt(5)
    v_mfma_f32_16x16x32_bf16 v[48:51], v[24:27], a[12:15], v[48:51]
    v_mfma_f32_16x16x32_bf16 v[52:55], v[24:27], a[92:95], v[52:55]
    s_barrier
    ds_read_b128 v[24:27], v2 offset:24576
    s_waitcnt lgkmcnt(5)
    v_mfma_f32_16x16x32_bf16 v[56:59], v[28:31], a[12:15], v[56:59]
    v_mfma_f32_16x16x32_bf16 v[60:63], v[28:31], a[92:95], v[60:63]
    ds_read_b128 v[28:31], v2 offset:25600
    buffer_load_dwordx4 a[36:39], v2, s[40:43], s58 offen offset:1024 sc1
    s_waitcnt lgkmcnt(5)
    v_mfma_f32_16x16x32_bf16 v[64:67], v[32:35], a[12:15], v[64:67]
    v_mfma_f32_16x16x32_bf16 v[68:71], v[32:35], a[92:95], v[68:71]
    ds_read_b128 v[32:35], v2 offset:26624
    s_waitcnt lgkmcnt(5)
    v_mfma_f32_16x16x32_bf16 v[72:75], v[36:39], a[12:15], v[72:75]
    v_mfma_f32_16x16x32_bf16 v[76:79], v[36:39], a[92:95], v[76:79]
    ds_read_b128 v[36:39], v2 offset:27648
    buffer_load_dwordx4 a[116:119], v2, s[40:43], s59 offen offset:1024 sc1
    s_waitcnt lgkmcnt(5)
    v_mfma_f32_16x16x32_bf16 v[80:83], v[40:43], a[12:15], v[80:83]
    v_mfma_f32_16x16x32_bf16 v[84:87], v[40:43], a[92:95], v[84:87]
    ds_read_b128 v[40:43], v2 offset:28672
    s_waitcnt lgkmcnt(5)
    v_mfma_f32_16x16x32_bf16 v[88:91], v[44:47], a[12:15], v[88:91]
    v_mfma_f32_16x16x32_bf16 v[92:95], v[44:47], a[92:95], v[92:95]
    ds_read_b128 v[44:47], v2 offset:29696
    s_waitcnt vmcnt(8)
    s_waitcnt lgkmcnt(5)
    v_mfma_f32_16x16x32_bf16 v[48:51], v[24:27], a[16:19], v[48:51]
    v_mfma_f32_16x16x32_bf16 v[52:55], v[24:27], a[96:99], v[52:55]
    ds_read_b128 v[24:27], v2 offset:30720
    s_waitcnt lgkmcnt(5)
    v_mfma_f32_16x16x32_bf16 v[56:59], v[28:31], a[16:19], v[56:59]
    v_mfma_f32_16x16x32_bf16 v[60:63], v[28:31], a[96:99], v[60:63]
    ds_read_b128 v[28:31], v2 offset:31744
    s_add_u32 s58, s22, s63
    s_add_u32 s59, s23, s63
    s_add_u32 s63, s63, 2048
    s_and_b32 s63, s63, 0x3fff
    buffer_load_dwordx4 a[40:43], v2, s[40:43], s58 offen offset:0 sc1
    s_waitcnt lgkmcnt(5)
    v_mfma_f32_16x16x32_bf16 v[64:67], v[32:35], a[16:19], v[64:67]
    v_mfma_f32_16x16x32_bf16 v[68:71], v[32:35], a[96:99], v[68:71]
    ds_read_b128 v[32:35], v2 offset:32768
    s_waitcnt lgkmcnt(5)
    v_mfma_f32_16x16x32_bf16 v[72:75], v[36:39], a[16:19], v[72:75]
    v_mfma_f32_16x16x32_bf16 v[76:79], v[36:39], a[96:99], v[76:79]
    ds_read_b128 v[36:39], v2 offset:33792
    buffer_load_dwordx4 a[120:123], v2, s[40:43], s59 offen offset:0 sc1
    s_waitcnt lgkmcnt(5)
    v_mfma_f32_16x16x32_bf16 v[80:83], v[40:43], a[16:19], v[80:83]
    v_mfma_f32_16x16x32_bf16 v[84:87], v[40:43], a[96:99], v[84:87]
    ds_read_b128 v[40:43], v2 offset:34816
    s_waitcnt lgkmcnt(5)
    v_mfma_f32_16x16x32_bf16 v[88:91], v[44:47], a[16:19], v[88:91]
    v_mfma_f32_16x16x32_bf16 v[92:95], v[44:47], a[96:99], v[92:95]
    ds_read_b128 v[44:47], v2 offset:35840
    s_waitcnt lgkmcnt(5)
    v_mfma_f32_16x16x32_bf16 v[48:51], v[24:27], a[20:23], v[48:51]
    v_mfma_f32_16x16x32_bf16 v[52:55], v[24:27], a[100:103], v[52:55]
    ds_read_b128 v[24:27], v2 offset:36864
    s_waitcnt lgkmcnt(5)
    v_mfma_f32_16x16x32_bf16 v[56:59], v[28:31], a[20:23], v[56:59]
    v_mfma_f32_16x16x32_bf16 v[60:63], v[28:31], a[100:103], v[60:63]
    ds_read_b128 v[28:31], v2 offset:37888
    buffer_load_dwordx4 a[44:47], v2, s[40:43], s58 offen offset:1024 sc1
    s_waitcnt lgkmcnt(5)
    v_mfma_f32_16x16x32_bf16 v[64:67], v[32:35], a[20:23], v[64:67]
    v_mfma_f32_16x16x32_bf16 v[68:71], v[32:35], a[100:103], v[68:71]
    ds_read_b128 v[32:35], v2 offset:38912
    s_waitcnt lgkmcnt(5)
    v_mfma_f32_16x16x32_bf16 v[72:75], v[36:39], a[20:23], v[72:75]
    v_mfma_f32_16x16x32_bf16 v[76:79], v[36:39], a[100:103], v[76:79]
    ds_read_b128 v[36:39], v2 offset:39936
    buffer_load_dwordx4 a[124:127], v2, s[40:43], s59 offen offset:1024 sc1
    s_waitcnt lgkmcnt(5)
    v_mfma_f32_16x16x32_bf16 v[80:83], v[40:43], a[20:23], v[80:83]
    v_mfma_f32_16x16x32_bf16 v[84:87], v[40:43], a[100:103], v[84:87]
    ds_read_b128 v[40:43], v2 offset:40960
    s_waitcnt lgkmcnt(5)
    v_mfma_f32_16x16x32_bf16 v[88:91], v[44:47], a[20:23], v[88:91]
    v_mfma_f32_16x16x32_bf16 v[92:95], v[44:47], a[100:103], v[92:95]
    ds_read_b128 v[44:47], v2 offset:41984
    s_waitcnt vmcnt(8)
    s_waitcnt lgkmcnt(5)
    v_mfma_f32_16x16x32_bf16 v[48:51], v[24:27], a[24:27], v[48:51]
    v_mfma_f32_16x16x32_bf16 v[52:55], v[24:27], a[104:107], v[52:55]
    ds_read_b128 v[24:27], v2 offset:43008
    s_waitcnt lgkmcnt(5)
    v_mfma_f32_16x16x32_bf16 v[56:59], v[28:31], a[24:27], v[56:59]
    v_mfma_f32_16x16x32_bf16 v[60:63], v[28:31], a[104:107], v[60:63]
    ds_read_b128 v[28:31], v2 offset:44032
    s_add_u32 s58, s22, s63
    s_add_u32 s59, s23, s63
    s_add_u32 s63, s63, 2048
    s_and_b32 s63, s63, 0x3fff
    buffer_load_dwordx4 a[48:51], v2, s[40:43], s58 offen offset:0 sc1
    s_waitcnt lgkmcnt(5)
    v_mfma_f32_16x16x32_bf16 v[64:67], v[32:35], a[24:27], v[64:67]
    v_mfma_f32_16x16x32_bf16 v[68:71], v[32:35], a[104:107], v[68:71]
    ds_read_b128 v[32:35], v2 offset:45056
    s_waitcnt lgkmcnt(5)
    v_mfma_f32_16x16x32_bf16 v[72:75], v[36:39], a[24:27], v[72:75]
    v_mfma_f32_16x16x32_bf16 v[76:79], v[36:39], a[104:107], v[76:79]
    ds_read_b128 v[36:39], v2 offset:46080
    buffer_load_dwordx4 a[128:131], v2, s[40:43], s59 offen offset:0 sc1
    s_waitcnt lgkmcnt(5)
    v_mfma_f32_16x16x32_bf16 v[80:83], v[40:43], a[24:27], v[80:83]
    v_mfma_f32_16x16x32_bf16 v[84:87], v[40:43], a[104:107], v[84:87]
    ds_read_b128 v[40:43], v2 offset:47104
    s_waitcnt lgkmcnt(5)
    v_mfma_f32_16x16x32_bf16 v[88:91], v[44:47], a[24:27], v[88:91]
    v_mfma_f32_16x16x32_bf16 v[92:95], v[44:47], a[104:107], v[92:95]
    ds_read_b128 v[44:47], v2 offset:48128
    s_waitcnt lgkmcnt(5)
    v_mfma_f32_16x16x32_bf16 v[48:51], v[24:27], a[28:31], v[48:51]
    v_mfma_f32_16x16x32_bf16 v[52:55], v[24:27], a[108:111], v[52:55]
    s_barrier
    ds_read_b128 v[24:27], v2 offset:49152
    s_waitcnt lgkmcnt(5)
    v_mfma_f32_16x16x32_bf16 v[56:59], v[28:31], a[28:31], v[56:59]
    v_mfma_f32_16x16x32_bf16 v[60:63], v[28:31], a[108:111], v[60:63]
    ds_read_b128 v[28:31], v2 offset:50176
    buffer_load_dwordx4 a[52:55], v2, s[40:43], s58 offen offset:1024 sc1
    s_waitcnt lgkmcnt(5)
    v_mfma_f32_16x16x32_bf16 v[64:67], v[32:35], a[28:31], v[64:67]
    v_mfma_f32_16x16x32_bf16 v[68:71], v[32:35], a[108:111], v[68:71]
    ds_read_b128 v[32:35], v2 offset:51200
    s_waitcnt lgkmcnt(5)
    v_mfma_f32_16x16x32_bf16 v[72:75], v[36:39], a[28:31], v[72:75]
    v_mfma_f32_16x16x32_bf16 v[76:79], v[36:39], a[108:111], v[76:79]
    ds_read_b128 v[36:39], v2 offset:52224
    buffer_load_dwordx4 a[132:135], v2, s[40:43], s59 offen offset:1024 sc1
    s_waitcnt lgkmcnt(5)
    v_mfma_f32_16x16x32_bf16 v[80:83], v[40:43], a[28:31], v[80:83]
    v_mfma_f32_16x16x32_bf16 v[84:87], v[40:43], a[108:111], v[84:87]
    ds_read_b128 v[40:43], v2 offset:53248
    s_waitcnt lgkmcnt(5)
    v_mfma_f32_16x16x32_bf16 v[88:91], v[44:47], a[28:31], v[88:91]
    v_mfma_f32_16x16x32_bf16 v[92:95], v[44:47], a[108:111], v[92:95]
    ds_read_b128 v[44:47], v2 offset:54272
    s_waitcnt vmcnt(8)
    s_waitcnt lgkmcnt(5)
    v_mfma_f32_16x16x32_bf16 v[48:51], v[24:27], a[32:35], v[48:51]
    v_mfma_f32_16x16x32_bf16 v[52:55], v[24:27], a[112:115], v[52:55]
    ds_read_b128 v[24:27], v2 offset:55296
    s_waitcnt lgkmcnt(5)
    v_mfma_f32_16x16x32_bf16 v[56:59], v[28:31], a[32:35], v[56:59]
    v_mfma_f32_16x16x32_bf16 v[60:63], v[28:31], a[112:115], v[60:63]
    ds_read_b128 v[28:31], v2 offset:56320
    s_add_u32 s58, s22, s63
    s_add_u32 s59, s23, s63
    s_add_u32 s63, s63, 2048
    s_and_b32 s63, s63, 0x3fff
    buffer_load_dwordx4 a[56:59], v2, s[40:43], s58 offen offset:0 sc1
    s_waitcnt lgkmcnt(5)
    v_mfma_f32_16x16x32_bf16 v[64:67], v[32:35], a[32:35], v[64:67]
    v_mfma_f32_16x16x32_bf16 v[68:71], v[32:35], a[112:115], v[68:71]
    ds_read_b128 v[32:35], v2 offset:57344
    s_waitcnt lgkmcnt(5)
    v_mfma_f32_16x16x32_bf16 v[72:75], v[36:39], a[32:35], v[72:75]
    v_mfma_f32_16x16x32_bf16 v[76:79], v[36:39], a[112:115], v[76:79]
    ds_read_b128 v[36:39], v2 offset:58368
    buffer_load_dwordx4 a[136:139], v2, s[40:43], s59 offen offset:0 sc1
    s_waitcnt lgkmcnt(5)
    v_mfma_f32_16x16x32_bf16 v[80:83], v[40:43], a[32:35], v[80:83]
    v_mfma_f32_16x16x32_bf16 v[84:87], v[40:43], a[112:115], v[84:87]
    ds_read_b128 v[40:43], v2 offset:59392
    s_waitcnt lgkmcnt(5)
    v_mfma_f32_16x16x32_bf16 v[88:91], v[44:47], a[32:35], v[88:91]
    v_mfma_f32_16x16x32_bf16 v[92:95], v[44:47], a[112:115], v[92:95]
    ds_read_b128 v[44:47], v2 offset:60416
    s_waitcnt lgkmcnt(5)
    v_mfma_f32_16x16x32_bf16 v[48:51], v[24:27], a[36:39], v[48:51]
    v_mfma_f32_16x16x32_bf16 v[52:55], v[24:27], a[116:119], v[52:55]
    ds_read_b128 v[24:27], v2 offset:61440
    s_waitcnt lgkmcnt(5)
    v_mfma_f32_16x16x32_bf16 v[56:59], v[28:31], a[36:39], v[56:59]
    v_mfma_f32_16x16x32_bf16 v[60:63], v[28:31], a[116:119], v[60:63]
    ds_read_b128 v[28:31], v2 offset:62464
    buffer_load_dwordx4 a[60:63], v2, s[40:43], s58 offen offset:1024 sc1
    s_waitcnt lgkmcnt(5)
    v_mfma_f32_16x16x32_bf16 v[64:67], v[32:35], a[36:39], v[64:67]
    v_mfma_f32_16x16x32_bf16 v[68:71], v[32:35], a[116:119], v[68:71]
    ds_read_b128 v[32:35], v2 offset:63488
    s_waitcnt lgkmcnt(5)
    v_mfma_f32_16x16x32_bf16 v[72:75], v[36:39], a[36:39], v[72:75]
    v_mfma_f32_16x16x32_bf16 v[76:79], v[36:39], a[116:119], v[76:79]
    ds_read_b128 v[36:39], v2 offset:64512
    buffer_load_dwordx4 a[140:143], v2, s[40:43], s59 offen offset:1024 sc1
    s_waitcnt lgkmcnt(5)
    v_mfma_f32_16x16x32_bf16 v[80:83], v[40:43], a[36:39], v[80:83]
    v_mfma_f32_16x16x32_bf16 v[84:87], v[40:43], a[116:119], v[84:87]
    ds_read_b128 v[40:43], v8 offset:0
    s_waitcnt lgkmcnt(5)
    v_mfma_f32_16x16x32_bf16 v[88:91], v[44:47], a[36:39], v[88:91]
    v_mfma_f32_16x16x32_bf16 v[92:95], v[44:47], a[116:119], v[92:95]
    ds_read_b128 v[44:47], v8 offset:1024
    s_waitcnt vmcnt(8)
    s_waitcnt lgkmcnt(5)
    v_mfma_f32_16x16x32_bf16 v[48:51], v[24:27], a[40:43], v[48:51]
    v_mfma_f32_16x16x32_bf16 v[52:55], v[24:27], a[120:123], v[52:55]
    ds_read_b128 v[24:27], v8 offset:2048
    s_waitcnt lgkmcnt(5)
    v_mfma_f32_16x16x32_bf16 v[56:59], v[28:31], a[40:43], v[56:59]
    v_mfma_f32_16x16x32_bf16 v[60:63], v[28:31], a[120:123], v[60:63]
    ds_read_b128 v[28:31], v8 offset:3072
    s_add_u32 s58, s22, 16384
    s_add_u32 s59, s23, 16384
    buffer_load_dwordx2 a[64:65], v3, s[40:43], s58 offen offset:0 sc1
    buffer_load_dwordx2 a[66:67], v3, s[40:43], s58 offen offset:512 sc1
    s_waitcnt lgkmcnt(5)
    v_mfma_f32_16x16x32_bf16 v[64:67], v[32:35], a[40:43], v[64:67]
    v_mfma_f32_16x16x32_bf16 v[68:71], v[32:35], a[120:123], v[68:71]
    ds_read_b128 v[32:35], v8 offset:4096
    s_waitcnt lgkmcnt(5)
    v_mfma_f32_16x16x32_bf16 v[72:75], v[36:39], a[40:43], v[72:75]
    v_mfma_f32_16x16x32_bf16 v[76:79], v[36:39], a[120:123], v[76:79]
    ds_read_b128 v[36:39], v8 offset:5120
    buffer_load_dwordx2 v[96:97], v3, s[40:43], s59 offen offset:0 sc1
    buffer_load_dwordx2 v[98:99], v3, s[40:43], s59 offen offset:512 sc1
    s_waitcnt lgkmcnt(5)
    v_mfma_f32_16x16x32_bf16 v[80:83], v[40:43], a[40:43], v[80:83]
    v_mfma_f32_16x16x32_bf16 v[84:87], v[40:43], a[120:123], v[84:87]
    ds_read_b128 v[40:43], v8 offset:6144
    s_waitcnt lgkmcnt(5)
    v_mfma_f32_16x16x32_bf16 v[88:91], v[44:47], a[40:43], v[88:91]
    v_mfma_f32_16x16x32_bf16 v[92:95], v[44:47], a[120:123], v[92:95]
    ds_read_b128 v[44:47], v8 offset:7168
    s_waitcnt lgkmcnt(5)
    v_mfma_f32_16x16x32_bf16 v[48:51], v[24:27], a[44:47], v[48:51]
    v_mfma_f32_16x16x32_bf16 v[52:55], v[24:27], a[124:127], v[52:55]
    s_barrier
    ds_read_b128 v[24:27], v8 offset:8192
    s_waitcnt lgkmcnt(5)
    v_mfma_f32_16x16x32_bf16 v[56:59], v[28:31], a[44:47], v[56:59]
    v_mfma_f32_16x16x32_bf16 v[60:63], v[28:31], a[124:127], v[60:63]
    ds_read_b128 v[28:31], v8 offset:9216
    buffer_load_dwordx2 a[68:69], v3, s[40:43], s58 offen offset:1024 sc1
    buffer_load_dwordx2 a[70:71], v3, s[40:43], s58 offen offset:1536 sc1
    s_waitcnt lgkmcnt(5)
    v_mfma_f32_16x16x32_bf16 v[64:67], v[32:35], a[44:47], v[64:67]
    v_mfma_f32_16x16x32_bf16 v[68:71], v[32:35], a[124:127], v[68:71]
    ds_read_b128 v[32:35], v8 offset:10240
    s_waitcnt lgkmcnt(5)
    v_mfma_f32_16x16x32_bf16 v[72:75], v[36:39], a[44:47], v[72:75]
    v_mfma_f32_16x16x32_bf16 v[76:79], v[36:39], a[124:127], v[76:79]
    ds_read_b128 v[36:39], v8 offset:11264
    buffer_load_dwordx2 v[100:101], v3, s[40:43], s59 offen offset:1024 sc1
    buffer_load_dwordx2 v[102:103], v3, s[40:43], s59 offen offset:1536 sc1
    s_waitcnt lgkmcnt(5)
    v_mfma_f32_16x16x32_bf16 v[80:83], v[40:43], a[44:47], v[80:83]
    v_mfma_f32_16x16x32_bf16 v[84:87], v[40:43], a[124:127], v[84:87]
    ds_read_b128 v[40:43], v8 offset:12288
    s_waitcnt lgkmcnt(5)
    v_mfma_f32_16x16x32_bf16 v[88:91], v[44:47], a[44:47], v[88:91]
    v_mfma_f32_16x16x32_bf16 v[92:95], v[44:47], a[124:127], v[92:95]
    ds_read_b128 v[44:47], v8 offset:13312
    s_waitcnt vmcnt(12)
    s_waitcnt lgkmcnt(5)
    v_mfma_f32_16x16x32_bf16 v[48:51], v[24:27], a[48:51], v[48:51]
    v_mfma_f32_16x16x32_bf16 v[52:55], v[24:27], a[128:131], v[52:55]
    ds_read_b128 v[24:27], v8 offset:14336
    s_waitcnt lgkmcnt(5)
    v_mfma_f32_16x16x32_bf16 v[56:59], v[28:31], a[48:51], v[56:59]
    v_mfma_f32_16x16x32_bf16 v[60:63], v[28:31], a[128:131], v[60:63]
    ds_read_b128 v[28:31], v8 offset:15360
    buffer_load_dwordx2 a[72:73], v3, s[40:43], s58 offen offset:2048 sc1
    buffer_load_dwordx2 a[74:75], v3, s[40:43], s58 offen offset:2560 sc1
    s_waitcnt lgkmcnt(5)
    v_mfma_f32_16x16x32_bf16 v[64:67], v[32:35], a[48:51], v[64:67]
    v_mfma_f32_16x16x32_bf16 v[68:71], v[32:35], a[128:131], v[68:71]
    ds_read_b128 v[32:35], v8 offset:16384
    s_waitcnt lgkmcnt(5)
    v_mfma_f32_16x16x32_bf16 v[72:75], v[36:39], a[48:51], v[72:75]
    v_mfma_f32_16x16x32_bf16 v[76:79], v[36:39], a[128:131], v[76:79]
    ds_read_b128 v[36:39], v8 offset:17408
    buffer_load_dwordx2 v[104:105], v3, s[40:43], s59 offen offset:2048 sc1
    buffer_load_dwordx2 v[106:107], v3, s[40:43], s59 offen offset:2560 sc1
    s_waitcnt lgkmcnt(5)
    v_mfma_f32_16x16x32_bf16 v[80:83], v[40:43], a[48:51], v[80:83]
    v_mfma_f32_16x16x32_bf16 v[84:87], v[40:43], a[128:131], v[84:87]
    ds_read_b128 v[40:43], v8 offset:18432
    s_waitcnt lgkmcnt(5)
    v_mfma_f32_16x16x32_bf16 v[88:91], v[44:47], a[48:51], v[88:91]
    v_mfma_f32_16x16x32_bf16 v[92:95], v[44:47], a[128:131], v[92:95]
    ds_read_b128 v[44:47], v8 offset:19456
    s_waitcnt lgkmcnt(5)
    v_mfma_f32_16x16x32_bf16 v[48:51], v[24:27], a[52:55], v[48:51]
    v_mfma_f32_16x16x32_bf16 v[52:55], v[24:27], a[132:135], v[52:55]
    ds_read_b128 v[24:27], v8 offset:20480
    s_waitcnt lgkmcnt(5)
    v_mfma_f32_16x16x32_bf16 v[56:59], v[28:31], a[52:55], v[56:59]
    v_mfma_f32_16x16x32_bf16 v[60:63], v[28:31], a[132:135], v[60:63]
    ds_read_b128 v[28:31], v8 offset:21504
    buffer_load_dwordx2 a[76:77], v3, s[40:43], s58 offen offset:3072 sc1
    buffer_load_dwordx2 a[78:79], v3, s[40:43], s58 offen offset:3584 sc1
    s_waitcnt lgkmcnt(5)
    v_mfma_f32_16x16x32_bf16 v[64:67], v[32:35], a[52:55], v[64:67]
    v_mfma_f32_16x16x32_bf16 v[68:71], v[32:35], a[132:135], v[68:71]
    ds_read_b128 v[32:35], v8 offset:22528
    s_waitcnt lgkmcnt(5)
    v_mfma_f32_16x16x32_bf16 v[72:75], v[36:39], a[52:55], v[72:75]
    v_mfma_f32_16x16x32_bf16 v[76:79], v[36:39], a[132:135], v[76:79]
    ds_read_b128 v[36:39], v8 offset:23552
    buffer_load_dwordx2 v[108:109], v3, s[40:43], s59 offen offset:3072 sc1
    buffer_load_dwordx2 v[110:111], v3, s[40:43], s59 offen offset:3584 sc1
    s_waitcnt lgkmcnt(5)
    v_mfma_f32_16x16x32_bf16 v[80:83], v[40:43], a[52:55], v[80:83]
    v_mfma_f32_16x16x32_bf16 v[84:87], v[40:43], a[132:135], v[84:87]
    ds_read_b128 v[40:43], v8 offset:24576
    s_waitcnt lgkmcnt(5)
    v_mfma_f32_16x16x32_bf16 v[88:91], v[44:47], a[52:55], v[88:91]
    v_mfma_f32_16x16x32_bf16 v[92:95], v[44:47], a[132:135], v[92:95]
    ds_read_b128 v[44:47], v8 offset:25600
    s_waitcnt vmcnt(16)
    s_waitcnt lgkmcnt(5)
    v_mfma_f32_16x16x32_bf16 v[48:51], v[24:27], a[56:59], v[48:51]
    v_mfma_f32_16x16x32_bf16 v[52:55], v[24:27], a[136:139], v[52:55]
    ds_read_b128 v[24:27], v8 offset:26624
    s_waitcnt lgkmcnt(5)
    v_mfma_f32_16x16x32_bf16 v[56:59], v[28:31], a[56:59], v[56:59]
    v_mfma_f32_16x16x32_bf16 v[60:63], v[28:31], a[136:139], v[60:63]
    ds_read_b128 v[28:31], v8 offset:27648
    s_waitcnt lgkmcnt(5)
    v_mfma_f32_16x16x32_bf16 v[64:67], v[32:35], a[56:59], v[64:67]
    v_mfma_f32_16x16x32_bf16 v[68:71], v[32:35], a[136:139], v[68:71]
    ds_read_b128 v[32:35], v8 offset:28672
    s_waitcnt lgkmcnt(5)
    v_mfma_f32_16x16x32_bf16 v[72:75], v[36:39], a[56:59], v[72:75]
    v_mfma_f32_16x16x32_bf16 v[76:79], v[36:39], a[136:139], v[76:79]
    ds_read_b128 v[36:39], v8 offset:29696
    s_waitcnt lgkmcnt(5)
    v_mfma_f32_16x16x32_bf16 v[80:83], v[40:43], a[56:59], v[80:83]
    v_mfma_f32_16x16x32_bf16 v[84:87], v[40:43], a[136:139], v[84:87]
    ds_read_b128 v[40:43], v8 offset:30720
    s_waitcnt lgkmcnt(5)
    v_mfma_f32_16x16x32_bf16 v[88:91], v[44:47], a[56:59], v[88:91]
    v_mfma_f32_16x16x32_bf16 v[92:95], v[44:47], a[136:139], v[92:95]
    ds_read_b128 v[44:47], v8 offset:31744
    s_waitcnt lgkmcnt(5)
    v_mfma_f32_16x16x32_bf16 v[48:51], v[24:27], a[60:63], v[48:51]
    v_mfma_f32_16x16x32_bf16 v[52:55], v[24:27], a[140:143], v[52:55]
    ds_read_b64 v[24:25], v7 offset:32768
    ds_read_b64 v[26:27], v7 offset:33280
    s_waitcnt lgkmcnt(6)
    v_mfma_f32_16x16x32_bf16 v[56:59], v[28:31], a[60:63], v[56:59]
    v_mfma_f32_16x16x32_bf16 v[60:63], v[28:31], a[140:143], v[60:63]
    ds_read_b64 v[28:29], v7 offset:33792
    ds_read_b64 v[30:31], v7 offset:34304
    s_waitcnt lgkmcnt(7)
    v_mfma_f32_16x16x32_bf16 v[64:67], v[32:35], a[60:63], v[64:67]
    v_mfma_f32_16x16x32_bf16 v[68:71], v[32:35], a[140:143], v[68:71]
    ds_read_b64 v[32:33], v7 offset:34816
    ds_read_b64 v[34:35], v7 offset:35328
    s_waitcnt lgkmcnt(8)
    v_mfma_f32_16x16x32_bf16 v[72:75], v[36:39], a[60:63], v[72:75]
    v_mfma_f32_16x16x32_bf16 v[76:79], v[36:39], a[140:143], v[76:79]
    ds_read_b64 v[36:37], v7 offset:35840
    ds_read_b64 v[38:39], v7 offset:36352
    s_waitcnt lgkmcnt(9)
    v_mfma_f32_16x16x32_bf16 v[80:83], v[40:43], a[60:63], v[80:83]
    v_mfma_f32_16x16x32_bf16 v[84:87], v[40:43], a[140:143], v[84:87]
    ds_read_b64 v[40:41], v7 offset:36864
    ds_read_b64 v[42:43], v7 offset:37376
    s_waitcnt lgkmcnt(10)
    v_mfma_f32_16x16x32_bf16 v[88:91], v[44:47], a[60:63], v[88:91]
    v_mfma_f32_16x16x32_bf16 v[92:95], v[44:47], a[140:143], v[92:95]
    ds_read_b64 v[44:45], v7 offset:37888
    ds_read_b64 v[46:47], v7 offset:38400
    s_waitcnt vmcnt(8)
    s_waitcnt lgkmcnt(10)
    v_mfma_f32_16x16x32_bf16 v[48:51], v[24:27], a[64:67], v[48:51]
    v_mfma_f32_16x16x32_bf16 v[52:55], v[24:27], v[96:99], v[52:55]
    ds_read_b64 v[24:25], v7 offset:38912
    ds_read_b64 v[26:27], v7 offset:39424
    s_waitcnt lgkmcnt(10)
    v_mfma_f32_16x16x32_bf16 v[56:59], v[28:31], a[64:67], v[56:59]
    v_mfma_f32_16x16x32_bf16 v[60:63], v[28:31], v[96:99], v[60:63]
    ds_read_b64 v[28:29], v7 offset:39936
    ds_read_b64 v[30:31], v7 offset:40448
    s_waitcnt lgkmcnt(10)
    v_mfma_f32_16x16x32_bf16 v[64:67], v[32:35], a[64:67], v[64:67]
    v_mfma_f32_16x16x32_bf16 v[68:71], v[32:35], v[96:99], v[68:71]
    ds_read_b64 v[32:33], v7 offset:40960
    ds_read_b64 v[34:35], v7 offset:41472
    s_waitcnt lgkmcnt(10)
    v_mfma_f32_16x16x32_bf16 v[72:75], v[36:39], a[64:67], v[72:75]
    v_mfma_f32_16x16x32_bf16 v[76:79], v[36:39], v[96:99], v[76:79]
    ds_read_b64 v[36:37], v7 offset:41984
    ds_read_b64 v[38:39], v7 offset:42496
    s_waitcnt lgkmcnt(10)
    v_mfma_f32_16x16x32_bf16 v[80:83], v[40:43], a[64:67], v[80:83]
    v_mfma_f32_16x16x32_bf16 v[84:87], v[40:43], v[96:99], v[84:87]
    ds_read_b64 v[40:41], v7 offset:43008
    ds_read_b64 v[42:43], v7 offset:43520
    s_waitcnt lgkmcnt(10)
    v_mfma_f32_16x16x32_bf16 v[88:91], v[44:47], a[64:67], v[88:91]
    v_mfma_f32_16x16x32_bf16 v[92:95], v[44:47], v[96:99], v[92:95]
    ds_read_b64 v[44:45], v7 offset:44032
    ds_read_b64 v[46:47], v7 offset:44544
    s_waitcnt lgkmcnt(10)
    v_mfma_f32_16x16x32_bf16 v[48:51], v[24:27], a[68:71], v[48:51]
    v_mfma_f32_16x16x32_bf16 v[52:55], v[24:27], v[100:103], v[52:55]
    ds_read_b64 v[24:25], v7 offset:45056
    ds_read_b64 v[26:27], v7 offset:45568
    s_waitcnt lgkmcnt(10)
    v_mfma_f32_16x16x32_bf16 v[56:59], v[28:31], a[68:71], v[56:59]
    v_mfma_f32_16x16x32_bf16 v[60:63], v[28:31], v[100:103], v[60:63]
    ds_read_b64 v[28:29], v7 offset:46080
    ds_read_b64 v[30:31], v7 offset:46592
    s_waitcnt lgkmcnt(10)
    v_mfma_f32_16x16x32_bf16 v[64:67], v[32:35], a[68:71], v[64:67]
    v_mfma_f32_16x16x32_bf16 v[68:71], v[32:35], v[100:103], v[68:71]
    ds_read_b64 v[32:33], v7 offset:47104
    ds_read_b64 v[34:35], v7 offset:47616
    s_waitcnt lgkmcnt(10)
    v_mfma_f32_16x16x32_bf16 v[72:75], v[36:39], a[68:71], v[72:75]
    v_mfma_f32_16x16x32_bf16 v[76:79], v[36:39], v[100:103], v[76:79]
    ds_read_b64 v[36:37], v7 offset:48128
    ds_read_b64 v[38:39], v7 offset:48640
    s_waitcnt lgkmcnt(10)
    v_mfma_f32_16x16x32_bf16 v[80:83], v[40:43], a[68:71], v[80:83]
    v_mfma_f32_16x16x32_bf16 v[84:87], v[40:43], v[100:103], v[84:87]
    ds_read_b64 v[40:41], v7 offset:49152
    ds_read_b64 v[42:43], v7 offset:49664
    s_waitcnt lgkmcnt(10)
    v_mfma_f32_16x16x32_bf16 v[88:91], v[44:47], a[68:71], v[88:91]
    v_mfma_f32_16x16x32_bf16 v[92:95], v[44:47], v[100:103], v[92:95]
    ds_read_b64 v[44:45], v7 offset:50176
    ds_read_b64 v[46:47], v7 offset:50688
    s_waitcnt vmcnt(0)
    s_waitcnt lgkmcnt(10)
    v_mfma_f32_16x16x32_bf16 v[48:51], v[24:27], a[72:75], v[48:51]
    v_mfma_f32_16x16x32_bf16 v[52:55], v[24:27], v[104:107], v[52:55]
    ds_read_b64 v[24:25], v7 offset:51200
    ds_read_b64 v[26:27], v7 offset:51712
    s_waitcnt lgkmcnt(10)
    v_mfma_f32_16x16x32_bf16 v[56:59], v[28:31], a[72:75], v[56:59]
    v_mfma_f32_16x16x32_bf16 v[60:63], v[28:31], v[104:107], v[60:63]
    ds_read_b64 v[28:29], v7 offset:52224
    ds_read_b64 v[30:31], v7 offset:52736
    s_waitcnt lgkmcnt(10)
    v_mfma_f32_16x16x32_bf16 v[64:67], v[32:35], a[72:75], v[64:67]
    v_mfma_f32_16x16x32_bf16 v[68:71], v[32:35], v[104:107], v[68:71]
    ds_read_b64 v[32:33], v7 offset:53248
    ds_read_b64 v[34:35], v7 offset:53760
    s_waitcnt lgkmcnt(10)
    v_mfma_f32_16x16x32_bf16 v[72:75], v[36:39], a[72:75], v[72:75]
    v_mfma_f32_16x16x32_bf16 v[76:79], v[36:39], v[104:107], v[76:79]
    ds_read_b64 v[36:37], v7 offset:54272
    ds_read_b64 v[38:39], v7 offset:54784
    s_waitcnt lgkmcnt(10)
    v_mfma_f32_16x16x32_bf16 v[80:83], v[40:43], a[72:75], v[80:83]
    v_mfma_f32_16x16x32_bf16 v[84:87], v[40:43], v[104:107], v[84:87]
    ds_read_b64 v[40:41], v7 offset:55296
    ds_read_b64 v[42:43], v7 offset:55808
    s_waitcnt lgkmcnt(10)
    v_mfma_f32_16x16x32_bf16 v[88:91], v[44:47], a[72:75], v[88:91]
    v_mfma_f32_16x16x32_bf16 v[92:95], v[44:47], v[104:107], v[92:95]
    ds_read_b64 v[44:45], v7 offset:56320
    ds_read_b64 v[46:47], v7 offset:56832
    s_waitcnt lgkmcnt(10)
    v_mfma_f32_16x16x32_bf16 v[48:51], v[24:27], a[76:79], v[48:51]
    s_waitcnt lgkmcnt(8)
    v_mfma_f32_16x16x32_bf16 v[56:59], v[28:31], a[76:79], v[56:59]
    s_waitcnt lgkmcnt(6)
    v_mfma_f32_16x16x32_bf16 v[64:67], v[32:35], a[76:79], v[64:67]
    s_waitcnt lgkmcnt(4)
    v_mfma_f32_16x16x32_bf16 v[72:75], v[36:39], a[76:79], v[72:75]
    s_waitcnt lgkmcnt(2)
    v_mfma_f32_16x16x32_bf16 v[80:83], v[40:43], a[76:79], v[80:83]
    s_waitcnt lgkmcnt(0)
    v_mfma_f32_16x16x32_bf16 v[88:91], v[44:47], a[76:79], v[88:91]
    v_mfma_f32_16x16x32_bf16 v[52:55], v[24:27], v[108:111], v[52:55]
    v_mfma_f32_16x16x32_bf16 v[60:63], v[28:31], v[108:111], v[60:63]
    v_mfma_f32_16x16x32_bf16 v[68:71], v[32:35], v[108:111], v[68:71]
    v_cvt_pk_bf16_f32 v48, v48, v49
    v_cvt_pk_bf16_f32 v49, v50, v51
    ds_write_b64 v9, v[48:49] offset:0
    v_mfma_f32_16x16x32_bf16 v[76:79], v[36:39], v[108:111], v[76:79]
    v_cvt_pk_bf16_f32 v56, v56, v57
    v_cvt_pk_bf16_f32 v57, v58, v59
    ds_write_b64 v9, v[56:57] offset:32
    v_mfma_f32_16x16x32_bf16 v[84:87], v[40:43], v[108:111], v[84:87]
    v_cvt_pk_bf16_f32 v64, v64, v65
    v_cvt_pk_bf16_f32 v65, v66, v67
    ds_write_b64 v9, v[64:65] offset:64
    v_mfma_f32_16x16x32_bf16 v[92:95], v[44:47], v[108:111], v[92:95]
    v_cvt_pk_bf16_f32 v72, v72, v73
    v_cvt_pk_bf16_f32 v73, v74, v75
    ds_write_b64 v9, v[72:73] offset:96
    v_cvt_pk_bf16_f32 v80, v80, v81
    v_cvt_pk_bf16_f32 v81, v82, v83
    ds_write_b64 v9, v[80:81] offset:128
    v_cvt_pk_bf16_f32 v88, v88, v89
    v_cvt_pk_bf16_f32 v89, v90, v91
    ds_write_b64 v9, v[88:89] offset:160
    ds_read_b128 v[48:51], v10 offset:0
    ds_read_b128 v[56:59], v11 offset:0
    ds_read_b128 v[64:67], v12 offset:0
    v_cvt_pk_bf16_f32 v52, v52, v53
    v_cvt_pk_bf16_f32 v53, v54, v55
    ds_write_b64 v9, v[52:53] offset:3328
    v_cvt_pk_bf16_f32 v60, v60, v61
    v_cvt_pk_bf16_f32 v61, v62, v63
    ds_write_b64 v9, v[60:61] offset:3360
    v_cvt_pk_bf16_f32 v68, v68, v69
    v_cvt_pk_bf16_f32 v69, v70, v71
    ds_write_b64 v9, v[68:69] offset:3392
    v_cvt_pk_bf16_f32 v76, v76, v77
    v_cvt_pk_bf16_f32 v77, v78, v79
    ds_write_b64 v9, v[76:77] offset:3424
    v_cvt_pk_bf16_f32 v84, v84, v85
    v_cvt_pk_bf16_f32 v85, v86, v87
    ds_write_b64 v9, v[84:85] offset:3456
    v_cvt_pk_bf16_f32 v92, v92, v93
    v_cvt_pk_bf16_f32 v93, v94, v95
    ds_write_b64 v9, v[92:93] offset:3488
    ds_read_b128 v[72:75], v10 offset:3328
    ds_read_b128 v[80:83], v11 offset:3328
    ds_read_b128 v[88:91], v12 offset:3328
    s_waitcnt lgkmcnt(11)
    buffer_store_dwordx4 v[48:51], v13, s[44:47], s61 offen sc1
    s_waitcnt lgkmcnt(10)
    buffer_store_dwordx4 v[56:59], v14, s[44:47], s61 offen sc1
    s_waitcnt lgkmcnt(9)
    buffer_store_dwordx4 v[64:67], v15, s[44:47], s61 offen sc1
    s_waitcnt lgkmcnt(2)
    buffer_store_dwordx4 v[72:75], v13, s[44:47], s62 offen sc1
    s_waitcnt lgkmcnt(1)
    buffer_store_dwordx4 v[80:83], v14, s[44:47], s62 offen sc1
    s_waitcnt lgkmcnt(0)
    buffer_store_dwordx4 v[88:91], v15, s[44:47], s62 offen sc1
    s_branch L_fin
L_loader:
    s_or_b32 s3, s2, s55
    s_cmp_lg_u32 s3, 0
    s_cbranch_scc1 L_nononce
    s_memrealtime s[22:23]
    v_mov_b32 v2, 0
    s_waitcnt lgkmcnt(0)
    s_mov_b32 s48, s18
    s_mov_b32 s49, s19
    s_mov_b32 s50, 256
    s_mov_b32 s51, 0x20000
    s_or_b32 s22, s22, 1
    v_mov_b32 v3, s22
    s_mov_b64 exec, 1
    buffer_store_dword v3, v2, s[48:51], 0 offen sc1
    s_mov_b64 exec, -1
L_nononce:
    v_and_b32 v2, 7, v1
    v_lshrrev_b32 v3, 3, v1
    s_cmp_lt_u32 s54, 8
    s_cbranch_scc1 L_xr_l
    s_mov_b32 s3, 3072
    v_lshlrev_b32 v16, 1, v5
    v_xor_b32 v16, v16, v2
    v_lshlrev_b32 v16, 4, v16
    v_mad_u32_u24 v6, v3, s3, v16
    v_add_u32 v7, 23552, v6
    v_add_u32 v8, 47104, v6
    v_add_u32 v9, 70656, v6
    s_mul_i32 s26, s55, 98304
    s_lshl_b32 s3, s57, 7
    s_add_u32 s26, s26, s3
    s_mul_i32 s22, s97, 3
    s_lshr_b32 s22, s22, 1
    s_mul_i32 s3, s98, 0
    s_add_u32 s22, s22, s3
    s_and_b32 s3, s96, 1
    s_add_u32 s22, s22, s3
    s_sub_u32 s3, s22, 12
    s_cselect_b32 s22, s22, s3
    s_sub_u32 s3, s22, 12
    s_cselect_b32 s22, s22, s3
    s_mul_i32 s24, s22, 393216
    s_lshl_b32 s25, s22, 12
    s_lshl_b32 s60, s55, 12
    s_waitcnt lgkmcnt(0)
    s_mov_b32 s28, s14
    s_mov_b32 s29, s15
    s_mov_b32 s30, 4718592
    s_mov_b32 s31, 0x20000
    s_barrier
    s_add_u32 m0, s60, 0
    s_add_u32 s58, s26, s24
    s_add_u32 s24, s24, 393216
    s_cmp_eq_u32 s24, 4718592
    s_cselect_b32 s24, 0, s24
    buffer_load_dwordx4 v6, s[28:31], s58 offen offset:0 lds
    buffer_load_dwordx4 v7, s[28:31], s58 offen offset:1024 lds
    buffer_load_dwordx4 v8, s[28:31], s58 offen offset:2048 lds
    buffer_load_dwordx4 v9, s[28:31], s58 offen offset:3072 lds
    s_add_u32 m0, s60, 16384
    s_add_u32 s58, s26, s24
    s_add_u32 s24, s24, 393216
    s_cmp_eq_u32 s24, 4718592
    s_cselect_b32 s24, 0, s24
    buffer_load_dwordx4 v6, s[28:31], s58 offen offset:0 lds
    buffer_load_dwordx4 v7, s[28:31], s58 offen offset:1024 lds
    buffer_load_dwordx4 v8, s[28:31], s58 offen offset:2048 lds
    buffer_load_dwordx4 v9, s[28:31], s58 offen offset:3072 lds
    s_mov_b32 s48, s18
    s_mov_b32 s49, s19
    s_mov_b32 s50, 256
    s_mov_b32 s51, 0x20000
    s_mov_b32 s40, s20
    s_mov_b32 s41, s21
    s_mov_b32 s42, 7340032
    s_mov_b32 s43, 0x20000
    v_lshlrev_b32 v10, 4, v1
    v_add_u32 v11, 48128, v10
    v_add_u32 v12, 96256, v10
    v_add_u32 v13, 144384, v10
    v_add_u32 v14, 196608, v10
    s_mul_i32 s27, s56, 245760
    s_lshl_b32 s3, s55, 10
    s_add_u32 s27, s27, s3
    s_add_u32 s27, s27, 4718592
    s_mul_i32 s61, s55, 5120
    s_add_u32 s61, s61, 32768
    s_mul_i32 s3, s56, 6144
    s_add_u32 s3, s3, 6946816
    v_min_u32 v22, 23, v1
    v_lshlrev_b32 v22, 8, v22
    v_add_u32 v22, s3, v22
    s_lshl_b32 s3, s57, 3
    s_add_u32 s3, s3, s56
    s_lshl_b32 s3, s3, 8
    s_add_u32 s92, s3, 7077888
    s_waitcnt vmcnt(4)
    s_add_u32 m0, s60, 32768
    s_add_u32 s58, s26, s24
    s_add_u32 s24, s24, 393216
    s_cmp_eq_u32 s24, 4718592
    s_cselect_b32 s24, 0, s24
    buffer_load_dwordx4 v6, s[28:31], s58 offen offset:0 lds
    buffer_load_dwordx4 v7, s[28:31], s58 offen offset:1024 lds
    buffer_load_dwordx4 v8, s[28:31], s58 offen offset:2048 lds
    buffer_load_dwordx4 v9, s[28:31], s58 offen offset:3072 lds
    s_waitcnt vmcnt(4)
    s_add_u32 m0, s60, 49152
    s_add_u32 s58, s26, s24
    s_add_u32 s24, s24, 393216
    s_cmp_eq_u32 s24, 4718592
    s_cselect_b32 s24, 0, s24
    buffer_load_dwordx4 v6, s[28:31], s58 offen offset:0 lds
    buffer_load_dwordx4 v7, s[28:31], s58 offen offset:1024 lds
    buffer_load_dwordx4 v8, s[28:31], s58 offen offset:2048 lds
    buffer_load_dwordx4 v9, s[28:31], s58 offen offset:3072 lds
    s_waitcnt vmcnt(8)
    s_barrier
    v_mov_b32 v21, 0
    buffer_load_dword v20, v21, s[48:51], 0 offen sc1
    s_add_u32 m0, s60, 65536
    s_add_u32 s58, s26, s24
    s_add_u32 s24, s24, 393216
    s_cmp_eq_u32 s24, 4718592
    s_cselect_b32 s24, 0, s24
    buffer_load_dwordx4 v6, s[28:31], s58 offen offset:0 lds
    buffer_load_dwordx4 v7, s[28:31], s58 offen offset:1024 lds
    buffer_load_dwordx4 v8, s[28:31], s58 offen offset:2048 lds
    buffer_load_dwordx4 v9, s[28:31], s58 offen offset:3072 lds
    s_add_u32 m0, s60, 81920
    s_add_u32 s58, s26, s24
    s_add_u32 s24, s24, 393216
    s_cmp_eq_u32 s24, 4718592
    s_cselect_b32 s24, 0, s24
    buffer_load_dwordx4 v6, s[28:31], s58 offen offset:0 lds
    buffer_load_dwordx4 v7, s[28:31], s58 offen offset:1024 lds
    buffer_load_dwordx4 v8, s[28:31], s58 offen offset:2048 lds
    buffer_load_dwordx4 v9, s[28:31], s58 offen offset:3072 lds
    s_add_u32 m0, s60, 98304
    s_add_u32 s58, s26, s24
    s_add_u32 s24, s24, 393216
    s_cmp_eq_u32 s24, 4718592
    s_cselect_b32 s24, 0, s24
    buffer_load_dwordx4 v6, s[28:31], s58 offen offset:0 lds
    buffer_load_dwordx4 v7, s[28:31], s58 offen offset:1024 lds
    buffer_load_dwordx4 v8, s[28:31], s58 offen offset:2048 lds
    buffer_load_dwordx4 v9, s[28:31], s58 offen offset:3072 lds
    s_add_u32 m0, s60, 114688
    s_add_u32 s58, s26, s24
    s_add_u32 s24, s24, 393216
    s_cmp_eq_u32 s24, 4718592
    s_cselect_b32 s24, 0, s24
    buffer_load_dwordx4 v6, s[28:31], s58 offen offset:0 lds
    buffer_load_dwordx4 v7, s[28:31], s58 offen offset:1024 lds
    buffer_load_dwordx4 v8, s[28:31], s58 offen offset:2048 lds
    buffer_load_dwordx4 v9, s[28:31], s58 offen offset:3072 lds
    s_waitcnt vmcnt(8)
    s_barrier
    s_add_u32 m0, s60, 131072
    s_add_u32 s58, s26, s24
    s_add_u32 s24, s24, 393216
    s_cmp_eq_u32 s24, 4718592
    s_cselect_b32 s24, 0, s24
    buffer_load_dwordx4 v6, s[28:31], s58 offen offset:0 lds
    buffer_load_dwordx4 v7, s[28:31], s58 offen offset:1024 lds
    buffer_load_dwordx4 v8, s[28:31], s58 offen offset:2048 lds
    buffer_load_dwordx4 v9, s[28:31], s58 offen offset:3072 lds
    s_add_u32 m0, s60, 147456
    s_add_u32 s58, s26, s24
    s_add_u32 s24, s24, 393216
    s_cmp_eq_u32 s24, 4718592
    s_cselect_b32 s24, 0, s24
    buffer_load_dwordx4 v6, s[28:31], s58 offen offset:0 lds
    buffer_load_dwordx4 v7, s[28:31], s58 offen offset:1024 lds
    buffer_load_dwordx4 v8, s[28:31], s58 offen offset:2048 lds
    buffer_load_dwordx4 v9, s[28:31], s58 offen offset:3072 lds
    s_add_u32 m0, s60, 0
    s_add_u32 s58, s26, s24
    s_add_u32 s24, s24, 393216
    s_cmp_eq_u32 s24, 4718592
    s_cselect_b32 s24, 0, s24
    buffer_load_dwordx4 v6, s[28:31], s58 offen offset:0 lds
    buffer_load_dwordx4 v7, s[28:31], s58 offen offset:1024 lds
    buffer_load_dwordx4 v8, s[28:31], s58 offen offset:2048 lds
    buffer_load_dwordx4 v9, s[28:31], s58 offen offset:3072 lds
    s_add_u32 m0, s60, 16384
    s_add_u32 s58, s26, s24
    s_add_u32 s24, s24, 393216
    s_cmp_eq_u32 s24, 4718592
    s_cselect_b32 s24, 0, s24
    buffer_load_dwordx4 v6, s[28:31], s58 offen offset:0 lds
    buffer_load_dwordx4 v7, s[28:31], s58 offen offset:1024 lds
    buffer_load_dwordx4 v8, s[28:31], s58 offen offset:2048 lds
    buffer_load_dwordx4 v9, s[28:31], s58 offen offset:3072 lds
    s_waitcnt vmcnt(8)
    s_mov_b32 s91, 0
Lnon_7:
    v_readfirstlane_b32 s90, v20
    s_add_u32 s91, s91, 1
    s_cmp_lg_u32 s90, 0
    s_cbranch_scc1 Lnon_8
    s_cmp_gt_u32 s91, 0x100000
    s_cbranch_scc1 L_end
    buffer_load_dword v20, v21, s[48:51], 0 offen sc1
    s_waitcnt vmcnt(0)
    s_branch Lnon_7
Lnon_8:
    s_cmp_lg_u32 s55, 0
    s_cbranch_scc1 L_nowp
    s_mov_b32 s91, 0
    buffer_load_dwordx4 v[16:19], v22, s[40:43], 0 offen sc1
    s_waitcnt vmcnt(0)
    v_xor_b32 v16, s90, v16
    v_xor_b32 v17, s90, v17
    v_xor_b32 v18, s90, v18
    v_xor_b32 v19, s90, v19
    v_or3_b32 v16, v16, v17, v18
    v_or_b32 v16, v16, v19
Lp_9:
    v_cmp_ne_u32 vcc, 0, v16
    s_add_u32 s91, s91, 1
    s_cmp_gt_u32 s91, 0x100000
    s_cbranch_scc1 L_end
    s_nop 2
    s_cbranch_vccz Lp_10
    buffer_load_dwordx4 v[16:19], v22, s[40:43], 0 offen sc1
    s_waitcnt vmcnt(0)
    v_xor_b32 v16, s90, v16
    v_xor_b32 v17, s90, v17
    v_xor_b32 v18, s90, v18
    v_xor_b32 v19, s90, v19
    v_or3_b32 v16, v16, v17, v18
    v_or_b32 v16, v16, v19
    s_branch Lp_9
Lp_10:
L_nowp:
    s_barrier
    s_add_u32 m0, s61, 0
    s_add_u32 s59, s27, s25
    s_add_u32 s25, s25, 4096
    s_cmp_eq_u32 s25, 49152
    s_cselect_b32 s25, 0, s25
    buffer_load_dwordx4 v10, s[40:43], s59 offen offset:0 sc1 lds
    buffer_load_dwordx4 v11, s[40:43], s59 offen offset:1024 sc1 lds
    buffer_load_dwordx4 v12, s[40:43], s59 offen offset:2048 sc1 lds
    buffer_load_dwordx4 v13, s[40:43], s59 offen offset:3072 sc1 lds
    s_add_u32 m0, s61, 4096
    s_nop 0
    buffer_load_dwordx4 v14, s[40:43], s59 offen sc1 lds
    s_add_u32 m0, s61, 20480
    s_add_u32 s59, s27, s25
    s_add_u32 s25, s25, 4096
    s_cmp_eq_u32 s25, 49152
    s_cselect_b32 s25, 0, s25
    buffer_load_dwordx4 v10, s[40:43], s59 offen offset:0 sc1 lds
    buffer_load_dwordx4 v11, s[40:43], s59 offen offset:1024 sc1 lds
    buffer_load_dwordx4 v12, s[40:43], s59 offen offset:2048 sc1 lds
    buffer_load_dwordx4 v13, s[40:43], s59 offen offset:3072 sc1 lds
    s_add_u32 m0, s61, 24576
    s_nop 0
    buffer_load_dwordx4 v14, s[40:43], s59 offen sc1 lds
    s_add_u32 m0, s61, 40960
    s_add_u32 s59, s27, s25
    s_add_u32 s25, s25, 4096
    s_cmp_eq_u32 s25, 49152
    s_cselect_b32 s25, 0, s25
    buffer_load_dwordx4 v10, s[40:43], s59 offen offset:0 sc1 lds
    buffer_load_dwordx4 v11, s[40:43], s59 offen offset:1024 sc1 lds
    buffer_load_dwordx4 v12, s[40:43], s59 offen offset:2048 sc1 lds
    buffer_load_dwordx4 v13, s[40:43], s59 offen offset:3072 sc1 lds
    s_add_u32 m0, s61, 45056
    s_nop 0
    buffer_load_dwordx4 v14, s[40:43], s59 offen sc1 lds
    s_waitcnt vmcnt(10)
    s_barrier
    s_add_u32 m0, s61, 61440
    s_add_u32 s59, s27, s25
    s_add_u32 s25, s25, 4096
    s_cmp_eq_u32 s25, 49152
    s_cselect_b32 s25, 0, s25
    buffer_load_dwordx4 v10, s[40:43], s59 offen offset:0 sc1 lds
    buffer_load_dwordx4 v11, s[40:43], s59 offen offset:1024 sc1 lds
    buffer_load_dwordx4 v12, s[40:43], s59 offen offset:2048 sc1 lds
    buffer_load_dwordx4 v13, s[40:43], s59 offen offset:3072 sc1 lds
    s_add_u32 m0, s61, 65536
    s_nop 0
    buffer_load_dwordx4 v14, s[40:43], s59 offen sc1 lds
    s_waitcnt vmcnt(10)
    s_barrier
    s_add_u32 m0, s61, 81920
    s_add_u32 s59, s27, s25
    s_add_u32 s25, s25, 4096
    s_cmp_eq_u32 s25, 49152
    s_cselect_b32 s25, 0, s25
    buffer_load_dwordx4 v10, s[40:43], s59 offen offset:0 sc1 lds
    buffer_load_dwordx4 v11, s[40:43], s59 offen offset:1024 sc1 lds
    buffer_load_dwordx4 v12, s[40:43], s59 offen offset:2048 sc1 lds
    buffer_load_dwordx4 v13, s[40:43], s59 offen offset:3072 sc1 lds
    s_add_u32 m0, s61, 86016
    s_nop 0
    buffer_load_dwordx4 v14, s[40:43], s59 offen sc1 lds
    s_waitcnt vmcnt(10)
    s_barrier
    s_add_u32 m0, s61, 102400
    s_add_u32 s59, s27, s25
    s_add_u32 s25, s25, 4096
    s_cmp_eq_u32 s25, 49152
    s_cselect_b32 s25, 0, s25
    buffer_load_dwordx4 v10, s[40:43], s59 offen offset:0 sc1 lds
    buffer_load_dwordx4 v11, s[40:43], s59 offen offset:1024 sc1 lds
    buffer_load_dwordx4 v12, s[40:43], s59 offen offset:2048 sc1 lds
    buffer_load_dwordx4 v13, s[40:43], s59 offen offset:3072 sc1 lds
    s_add_u32 m0, s61, 106496
    s_nop 0
    buffer_load_dwordx4 v14, s[40:43], s59 offen sc1 lds
    s_waitcnt vmcnt(10)
    s_barrier
    s_add_u32 m0, s61, 0
    s_add_u32 s59, s27, s25
    s_add_u32 s25, s25, 4096
    s_cmp_eq_u32 s25, 49152
    s_cselect_b32 s25, 0, s25
    buffer_load_dwordx4 v10, s[40:43], s59 offen offset:0 sc1 lds
    buffer_load_dwordx4 v11, s[40:43], s59 offen offset:1024 sc1 lds
    buffer_load_dwordx4 v12, s[40:43], s59 offen offset:2048 sc1 lds
    buffer_load_dwordx4 v13, s[40:43], s59 offen offset:3072 sc1 lds
    s_add_u32 m0, s61, 4096
    s_nop 0
    buffer_load_dwordx4 v14, s[40:43], s59 offen sc1 lds
    s_waitcnt vmcnt(10)
    s_barrier
    s_add_u32 m0, s61, 20480
    s_add_u32 s59, s27, s25
    s_add_u32 s25, s25, 4096
    s_cmp_eq_u32 s25, 49152
    s_cselect_b32 s25, 0, s25
    buffer_load_dwordx4 v10, s[40:43], s59 offen offset:0 sc1 lds
    buffer_load_dwordx4 v11, s[40:43], s59 offen offset:1024 sc1 lds
    buffer_load_dwordx4 v12, s[40:43], s59 offen offset:2048 sc1 lds
    buffer_load_dwordx4 v13, s[40:43], s59 offen offset:3072 sc1 lds
    s_add_u32 m0, s61, 24576
    s_nop 0
    buffer_load_dwordx4 v14, s[40:43], s59 offen sc1 lds
    s_waitcnt vmcnt(10)
    s_barrier
    s_add_u32 m0, s61, 40960
    s_add_u32 s59, s27, s25
    s_add_u32 s25, s25, 4096
    s_cmp_eq_u32 s25, 49152
    s_cselect_b32 s25, 0, s25
    buffer_load_dwordx4 v10, s[40:43], s59 offen offset:0 sc1 lds
    buffer_load_dwordx4 v11, s[40:43], s59 offen offset:1024 sc1 lds
    buffer_load_dwordx4 v12, s[40:43], s59 offen offset:2048 sc1 lds
    buffer_load_dwordx4 v13, s[40:43], s59 offen offset:3072 sc1 lds
    s_add_u32 m0, s61, 45056
    s_nop 0
    buffer_load_dwordx4 v14, s[40:43], s59 offen sc1 lds
    s_waitcnt vmcnt(10)
    s_barrier
    s_add_u32 m0, s61, 61440
    s_add_u32 s59, s27, s25
    s_add_u32 s25, s25, 4096
    s_cmp_eq_u32 s25, 49152
    s_cselect_b32 s25, 0, s25
    buffer_load_dwordx4 v10, s[40:43], s59 offen offset:0 sc1 lds
    buffer_load_dwordx4 v11, s[40:43], s59 offen offset:1024 sc1 lds
    buffer_load_dwordx4 v12, s[40:43], s59 offen offset:2048 sc1 lds
    buffer_load_dwordx4 v13, s[40:43], s59 offen offset:3072 sc1 lds
    s_add_u32 m0, s61, 65536
    s_nop 0
    buffer_load_dwordx4 v14, s[40:43], s59 offen sc1 lds
    s_waitcnt vmcnt(10)
    s_barrier
    s_add_u32 m0, s61, 81920
    s_add_u32 s59, s27, s25
    s_add_u32 s25, s25, 4096
    s_cmp_eq_u32 s25, 49152
    s_cselect_b32 s25, 0, s25
    buffer_load_dwordx4 v10, s[40:43], s59 offen offset:0 sc1 lds
    buffer_load_dwordx4 v11, s[40:43], s59 offen offset:1024 sc1 lds
    buffer_load_dwordx4 v12, s[40:43], s59 offen offset:2048 sc1 lds
    buffer_load_dwordx4 v13, s[40:43], s59 offen offset:3072 sc1 lds
    s_add_u32 m0, s61, 86016
    s_nop 0
    buffer_load_dwordx4 v14, s[40:43], s59 offen sc1 lds
    s_waitcnt vmcnt(10)
    s_barrier
    s_add_u32 m0, s61, 102400
    s_add_u32 s59, s27, s25
    s_add_u32 s25, s25, 4096
    s_cmp_eq_u32 s25, 49152
    s_cselect_b32 s25, 0, s25
    buffer_load_dwordx4 v10, s[40:43], s59 offen offset:0 sc1 lds
    buffer_load_dwordx4 v11, s[40:43], s59 offen offset:1024 sc1 lds
    buffer_load_dwordx4 v12, s[40:43], s59 offen offset:2048 sc1 lds
    buffer_load_dwordx4 v13, s[40:43], s59 offen offset:3072 sc1 lds
    s_add_u32 m0, s61, 106496
    s_nop 0
    buffer_load_dwordx4 v14, s[40:43], s59 offen sc1 lds
    s_waitcnt vmcnt(10)
    s_barrier
    s_waitcnt vmcnt(5)
    s_barrier
    s_waitcnt vmcnt(0)
    s_barrier
    s_barrier
    s_branch L_p2_l
L_xr_l:
    s_lshl_b32 s3, s57, 2
    s_add_u32 s3, s3, s55
    s_mul_i32 s32, s3, 40960
    s_mul_i32 s33, s55, 20480
    s_mul_i32 s3, s56, 320
    s_add_u32 s33, s33, s3
    s_mul_i32 s22, s56, 5
    s_lshr_b32 s22, s22, 1
    s_lshr_b32 s3, s54, 2
    s_mul_i32 s3, s3, 5
    s_add_u32 s22, s22, s3
    s_add_u32 s22, s22, s96
    s_sub_u32 s3, s22, 10
    s_cselect_b32 s22, s22, s3
    s_sub_u32 s3, s22, 10
    s_cselect_b32 s22, s22, s3
    s_lshl_b32 s34, s22, 7
    s_lshl_b32 s3, s57, 2
    s_add_u32 s3, s3, s56
    s_lshl_b32 s3, s3, 8
    s_add_u32 s92, s3, 6881280
    s_lshl_b32 s60, s55, 12
    s_mul_i32 s61, s55, 5120
    s_add_u32 s61, s61, 16384
    s_mov_b32 s23, 1280
    v_xor_b32 v16, v2, v5
    v_lshlrev_b32 v16, 4, v16
    v_mad_u32_u24 v6, v3, s23, v16
    v_xor_b32 v16, 64, v16
    v_mad_u32_u24 v7, v3, s23, v16
    v_add_u32 v7, 9216, v7
    v_add_u32 v8, 18432, v6
    v_add_u32 v9, 18432, v7
    s_waitcnt lgkmcnt(0)
    s_mov_b32 s24, s4
    s_mov_b32 s25, s5
    s_mov_b32 s26, 2621440
    s_mov_b32 s27, 0x20000
    s_add_u32 m0, s60, 0
    s_add_u32 s58, s32, s34
    s_mul_i32 s59, s34, 640
    s_add_u32 s59, s59, s33
    s_add_u32 s34, s34, 128
    s_cmp_eq_u32 s34, 1280
    s_cselect_b32 s34, 0, s34
    buffer_load_dwordx4 v6, s[24:27], s58 offen offset:0 lds
    buffer_load_dwordx4 v7, s[24:27], s58 offen offset:1024 lds
    buffer_load_dwordx4 v8, s[24:27], s58 offen offset:2048 lds
    buffer_load_dwordx4 v9, s[24:27], s58 offen offset:3072 lds
    s_mov_b32 s28, s12
    s_mov_b32 s29, s13
    s_mov_b32 s30, 819200
    s_mov_b32 s31, 0x20000
    s_mov_b32 s48, s18
    s_mov_b32 s49, s19
    s_mov_b32 s50, 256
    s_mov_b32 s51, 0x20000
    s_mov_b32 s40, s20
    s_mov_b32 s41, s21
    s_mov_b32 s42, 7340032
    s_mov_b32 s43, 0x20000
    v_add_u32 v16, 0, v1
    v_mul_u32_u24 v17, 3277, v16
    v_lshrrev_b32 v17, 16, v17
    v_mul_u32_u24 v18, 20, v17
    v_sub_u32 v18, v16, v18
    v_lshrrev_b32 v16, 3, v17
    v_lshlrev_b32 v16, 1, v16
    v_xor_b32 v18, v18, v16
    v_lshlrev_b32 v18, 4, v18
    v_mad_u32_u24 v10, v17, s23, v18
    v_add_u32 v16, 64, v1
    v_mul_u32_u24 v17, 3277, v16
    v_lshrrev_b32 v17, 16, v17
    v_mul_u32_u24 v18, 20, v17
    v_sub_u32 v18, v16, v18
    v_lshrrev_b32 v16, 3, v17
    v_lshlrev_b32 v16, 1, v16
    v_xor_b32 v18, v18, v16
    v_lshlrev_b32 v18, 4, v18
    v_mad_u32_u24 v11, v17, s23, v18
    v_subrev_u32 v11, 1024, v11
    v_add_u32 v16, 128, v1
    v_mul_u32_u24 v17, 3277, v16
    v_lshrrev_b32 v17, 16, v17
    v_mul_u32_u24 v18, 20, v17
    v_sub_u32 v18, v16, v18
    v_lshrrev_b32 v16, 3, v17
    v_lshlrev_b32 v16, 1, v16
    v_xor_b32 v18, v18, v16
    v_lshlrev_b32 v18, 4, v18
    v_mad_u32_u24 v12, v17, s23, v18
    v_subrev_u32 v12, 2048, v12
    v_add_u32 v16, 192, v1
    v_mul_u32_u24 v17, 3277, v16
    v_lshrrev_b32 v17, 16, v17
    v_mul_u32_u24 v18, 20, v17
    v_sub_u32 v18, v16, v18
    v_lshrrev_b32 v16, 3, v17
    v_lshlrev_b32 v16, 1, v16
    v_xor_b32 v18, v18, v16
    v_lshlrev_b32 v18, 4, v18
    v_mad_u32_u24 v13, v17, s23, v18
    v_subrev_u32 v13, 3072, v13
    v_add_u32 v16, 256, v1
    v_mul_u32_u24 v17, 3277, v16
    v_lshrrev_b32 v17, 16, v17
    v_mul_u32_u24 v18, 20, v17
    v_sub_u32 v18, v16, v18
    v_lshrrev_b32 v16, 3, v17
    v_lshlrev_b32 v16, 1, v16
    v_xor_b32 v18, v18, v16
    v_lshlrev_b32 v18, 4, v18
    v_mad_u32_u24 v14, v17, s23, v18
    s_add_u32 m0, s61, 0
    s_nop 0
    buffer_load_dwordx4 v10, s[28:31], s59 offen offset:0 lds
    buffer_load_dwordx4 v11, s[28:31], s59 offen offset:1024 lds
    buffer_load_dwordx4 v12, s[28:31], s59 offen offset:2048 lds
    buffer_load_dwordx4 v13, s[28:31], s59 offen offset:3072 lds
    s_add_u32 m0, s61, 4096
    s_nop 0
    buffer_load_dwordx4 v14, s[28:31], s59 offen lds
    s_add_u32 m0, s60, 36864
    s_add_u32 s58, s32, s34
    s_mul_i32 s59, s34, 640
    s_add_u32 s59, s59, s33
    s_add_u32 s34, s34, 128
    s_cmp_eq_u32 s34, 1280
    s_cselect_b32 s34, 0, s34
    buffer_load_dwordx4 v6, s[24:27], s58 offen offset:0 lds
    buffer_load_dwordx4 v7, s[24:27], s58 offen offset:1024 lds
    buffer_load_dwordx4 v8, s[24:27], s58 offen offset:2048 lds
    buffer_load_dwordx4 v9, s[24:27], s58 offen offset:3072 lds
    s_add_u32 m0, s61, 36864
    s_nop 0
    buffer_load_dwordx4 v10, s[28:31], s59 offen offset:0 lds
    buffer_load_dwordx4 v11, s[28:31], s59 offen offset:1024 lds
    buffer_load_dwordx4 v12, s[28:31], s59 offen offset:2048 lds
    buffer_load_dwordx4 v13, s[28:31], s59 offen offset:3072 lds
    s_add_u32 m0, s61, 40960
    s_nop 0
    buffer_load_dwordx4 v14, s[28:31], s59 offen lds
    s_waitcnt vmcnt(9)
    s_barrier
    s_add_u32 m0, s60, 73728
    s_add_u32 s58, s32, s34
    s_mul_i32 s59, s34, 640
    s_add_u32 s59, s59, s33
    s_add_u32 s34, s34, 128
    s_cmp_eq_u32 s34, 1280
    s_cselect_b32 s34, 0, s34
    buffer_load_dwordx4 v6, s[24:27], s58 offen offset:0 lds
    buffer_load_dwordx4 v7, s[24:27], s58 offen offset:1024 lds
    buffer_load_dwordx4 v8, s[24:27], s58 offen offset:2048 lds
    buffer_load_dwordx4 v9, s[24:27], s58 offen offset:3072 lds
    s_add_u32 m0, s61, 73728
    s_nop 0
    buffer_load_dwordx4 v10, s[28:31], s59 offen offset:0 lds
    buffer_load_dwordx4 v11, s[28:31], s59 offen offset:1024 lds
    buffer_load_dwordx4 v12, s[28:31], s59 offen offset:2048 lds
    buffer_load_dwordx4 v13, s[28:31], s59 offen offset:3072 lds
    s_add_u32 m0, s61, 77824
    s_nop 0
    buffer_load_dwordx4 v14, s[28:31], s59 offen lds
    s_waitcnt vmcnt(9)
    s_barrier
    s_add_u32 m0, s60, 110592
    s_add_u32 s58, s32, s34
    s_mul_i32 s59, s34, 640
    s_add_u32 s59, s59, s33
    s_add_u32 s34, s34, 128
    s_cmp_eq_u32 s34, 1280
    s_cselect_b32 s34, 0, s34
    buffer_load_dwordx4 v6, s[24:27], s58 offen offset:0 lds
    buffer_load_dwordx4 v7, s[24:27], s58 offen offset:1024 lds
    buffer_load_dwordx4 v8, s[24:27], s58 offen offset:2048 lds
    buffer_load_dwordx4 v9, s[24:27], s58 offen offset:3072 lds
    s_add_u32 m0, s61, 110592
    s_nop 0
    buffer_load_dwordx4 v10, s[28:31], s59 offen offset:0 lds
    buffer_load_dwordx4 v11, s[28:31], s59 offen offset:1024 lds
    buffer_load_dwordx4 v12, s[28:31], s59 offen offset:2048 lds
    buffer_load_dwordx4 v13, s[28:31], s59 offen offset:3072 lds
    s_add_u32 m0, s61, 114688
    s_nop 0
    buffer_load_dwordx4 v14, s[28:31], s59 offen lds
    s_waitcnt vmcnt(9)
    s_barrier
    s_add_u32 m0, s60, 0
    s_add_u32 s58, s32, s34
    s_mul_i32 s59, s34, 640
    s_add_u32 s59, s59, s33
    s_add_u32 s34, s34, 128
    s_cmp_eq_u32 s34, 1280
    s_cselect_b32 s34, 0, s34
    buffer_load_dwordx4 v6, s[24:27], s58 offen offset:0 lds
    buffer_load_dwordx4 v7, s[24:27], s58 offen offset:1024 lds
    buffer_load_dwordx4 v8, s[24:27], s58 offen offset:2048 lds
    buffer_load_dwordx4 v9, s[24:27], s58 offen offset:3072 lds
    s_add_u32 m0, s61, 0
    s_nop 0
    buffer_load_dwordx4 v10, s[28:31], s59 offen offset:0 lds
    buffer_load_dwordx4 v11, s[28:31], s59 offen offset:1024 lds
    buffer_load_dwordx4 v12, s[28:31], s59 offen offset:2048 lds
    buffer_load_dwordx4 v13, s[28:31], s59 offen offset:3072 lds
    s_add_u32 m0, s61, 4096
    s_nop 0
    buffer_load_dwordx4 v14, s[28:31], s59 offen lds
    s_waitcnt vmcnt(9)
    s_barrier
    s_add_u32 m0, s60, 36864
    s_add_u32 s58, s32, s34
    s_mul_i32 s59, s34, 640
    s_add_u32 s59, s59, s33
    s_add_u32 s34, s34, 128
    s_cmp_eq_u32 s34, 1280
    s_cselect_b32 s34, 0, s34
    buffer_load_dwordx4 v6, s[24:27], s58 offen offset:0 lds
    buffer_load_dwordx4 v7, s[24:27], s58 offen offset:1024 lds
    buffer_load_dwordx4 v8, s[24:27], s58 offen offset:2048 lds
    buffer_load_dwordx4 v9, s[24:27], s58 offen offset:3072 lds
    s_add_u32 m0, s61, 36864
    s_nop 0
    buffer_load_dwordx4 v10, s[28:31], s59 offen offset:0 lds
    buffer_load_dwordx4 v11, s[28:31], s59 offen offset:1024 lds
    buffer_load_dwordx4 v12, s[28:31], s59 offen offset:2048 lds
    buffer_load_dwordx4 v13, s[28:31], s59 offen offset:3072 lds
    s_add_u32 m0, s61, 40960
    s_nop 0
    buffer_load_dwordx4 v14, s[28:31], s59 offen lds
    s_waitcnt vmcnt(9)
    s_barrier
    s_add_u32 m0, s60, 73728
    s_add_u32 s58, s32, s34
    s_mul_i32 s59, s34, 640
    s_add_u32 s59, s59, s33
    s_add_u32 s34, s34, 128
    s_cmp_eq_u32 s34, 1280
    s_cselect_b32 s34, 0, s34
    buffer_load_dwordx4 v6, s[24:27], s58 offen offset:0 lds
    buffer_load_dwordx4 v7, s[24:27], s58 offen offset:1024 lds
    buffer_load_dwordx4 v8, s[24:27], s58 offen offset:2048 lds
    buffer_load_dwordx4 v9, s[24:27], s58 offen offset:3072 lds
    s_add_u32 m0, s61, 73728
    s_nop 0
    buffer_load_dwordx4 v10, s[28:31], s59 offen offset:0 lds
    buffer_load_dwordx4 v11, s[28:31], s59 offen offset:1024 lds
    buffer_load_dwordx4 v12, s[28:31], s59 offen offset:2048 lds
    buffer_load_dwordx4 v13, s[28:31], s59 offen offset:3072 lds
    s_add_u32 m0, s61, 77824
    s_nop 0
    buffer_load_dwordx4 v14, s[28:31], s59 offen lds
    s_waitcnt vmcnt(9)
    s_barrier
    s_add_u32 m0, s60, 110592
    s_add_u32 s58, s32, s34
    s_mul_i32 s59, s34, 640
    s_add_u32 s59, s59, s33
    s_add_u32 s34, s34, 128
    s_cmp_eq_u32 s34, 1280
    s_cselect_b32 s34, 0, s34
    buffer_load_dwordx4 v6, s[24:27], s58 offen offset:0 lds
    buffer_load_dwordx4 v7, s[24:27], s58 offen offset:1024 lds
    buffer_load_dwordx4 v8, s[24:27], s58 offen offset:2048 lds
    buffer_load_dwordx4 v9, s[24:27], s58 offen offset:3072 lds
    s_add_u32 m0, s61, 110592
    s_nop 0
    buffer_load_dwordx4 v10, s[28:31], s59 offen offset:0 lds
    buffer_load_dwordx4 v11, s[28:31], s59 offen offset:1024 lds
    buffer_load_dwordx4 v12, s[28:31], s59 offen offset:2048 lds
    buffer_load_dwordx4 v13, s[28:31], s59 offen offset:3072 lds
    s_add_u32 m0, s61, 114688
    s_nop 0
    buffer_load_dwordx4 v14, s[28:31], s59 offen lds
    s_waitcnt vmcnt(9)
    s_barrier
    s_add_u32 m0, s60, 0
    s_add_u32 s58, s32, s34
    s_mul_i32 s59, s34, 640
    s_add_u32 s59, s59, s33
    s_add_u32 s34, s34, 128
    s_cmp_eq_u32 s34, 1280
    s_cselect_b32 s34, 0, s34
    buffer_load_dwordx4 v6, s[24:27], s58 offen offset:0 lds
    buffer_load_dwordx4 v7, s[24:27], s58 offen offset:1024 lds
    buffer_load_dwordx4 v8, s[24:27], s58 offen offset:2048 lds
    buffer_load_dwordx4 v9, s[24:27], s58 offen offset:3072 lds
    s_add_u32 m0, s61, 0
    s_nop 0
    buffer_load_dwordx4 v10, s[28:31], s59 offen offset:0 lds
    buffer_load_dwordx4 v11, s[28:31], s59 offen offset:1024 lds
    buffer_load_dwordx4 v12, s[28:31], s59 offen offset:2048 lds
    buffer_load_dwordx4 v13, s[28:31], s59 offen offset:3072 lds
    s_add_u32 m0, s61, 4096
    s_nop 0
    buffer_load_dwordx4 v14, s[28:31], s59 offen lds
    s_waitcnt vmcnt(9)
    s_barrier
    s_add_u32 m0, s60, 36864
    s_add_u32 s58, s32, s34
    s_mul_i32 s59, s34, 640
    s_add_u32 s59, s59, s33
    s_add_u32 s34, s34, 128
    s_cmp_eq_u32 s34, 1280
    s_cselect_b32 s34, 0, s34
    buffer_load_dwordx4 v6, s[24:27], s58 offen offset:0 lds
    buffer_load_dwordx4 v7, s[24:27], s58 offen offset:1024 lds
    buffer_load_dwordx4 v8, s[24:27], s58 offen offset:2048 lds
    buffer_load_dwordx4 v9, s[24:27], s58 offen offset:3072 lds
    s_add_u32 m0, s61, 36864
    s_nop 0
    buffer_load_dwordx4 v10, s[28:31], s59 offen offset:0 lds
    buffer_load_dwordx4 v11, s[28:31], s59 offen offset:1024 lds
    buffer_load_dwordx4 v12, s[28:31], s59 offen offset:2048 lds
    buffer_load_dwordx4 v13, s[28:31], s59 offen offset:3072 lds
    s_add_u32 m0, s61, 40960
    s_nop 0
    buffer_load_dwordx4 v14, s[28:31], s59 offen lds
    s_waitcnt vmcnt(9)
    s_barrier
    s_waitcnt vmcnt(0)
    s_barrier
    s_barrier
    v_mov_b32 v21, 0
    buffer_load_dword v20, v21, s[48:51], 0 offen sc1
    s_waitcnt vmcnt(0)
    s_mov_b32 s91, 0
Lnon_11:
    v_readfirstlane_b32 s90, v20
    s_add_u32 s91, s91, 1
    s_cmp_lg_u32 s90, 0
    s_cbranch_scc1 Lnon_12
    s_cmp_gt_u32 s91, 0x100000
    s_cbranch_scc1 L_end
    buffer_load_dword v20, v21, s[48:51], 0 offen sc1
    s_waitcnt vmcnt(0)
    s_branch Lnon_11
Lnon_12:
L_p2_l:
    s_mul_i32 s3, s94, 3
    s_lshr_b32 s3, s3, 1
    s_lshl_b32 s3, s3, 11
    s_add_u32 s61, s3, 7077888
    v_lshlrev_b32 v23, 8, v4
    v_add_u32 v23, s61, v23
    v_mov_b32 v8, 163832
    v_mov_b32 v9, 0
    ds_write_b32 v8, v9
    v_lshlrev_b32 v2, 4, v1
    v_add_u32 v6, 19456, v2
    v_add_u32 v7, 38912, v2
    s_and_b32 s3, s55, 1
    s_mul_i32 s22, s94, 6
    s_mul_i32 s23, s3, 3
    s_add_u32 s22, s22, s23
    s_mul_i32 s58, s22, 20480
    s_lshr_b32 s22, s55, 1
    s_lshl_b32 s23, s22, 10
    s_add_u32 s58, s58, s23
    s_mul_i32 s60, s22, 6144
    s_mul_i32 s3, s3, 3072
    s_add_u32 s60, s60, s3
    s_mov_b32 s63, s95
    s_cmp_lg_u32 s55, 0
    s_waitcnt lgkmcnt(0)
    s_barrier
    s_cbranch_scc1 L_nofs
    v_mov_b32 v21, s92
    s_mov_b64 exec, 1
    buffer_store_dword v20, v21, s[40:43], 0 offen sc1
    s_mov_b64 exec, -1
L_nofs:
    s_cmp_lg_u32 s55, 2
    s_cbranch_scc1 L_tw
    s_mov_b32 s91, 0
    buffer_load_dword v16, v23, s[40:43], 0 offen sc1
    s_waitcnt vmcnt(0)
Lp_13:
    v_cmp_ne_u32 vcc, s90, v16
    s_add_u32 s91, s91, 1
    s_cmp_gt_u32 s91, 0x100000
    s_cbranch_scc1 L_end
    s_nop 2
    s_cbranch_vccz Lp_14
    buffer_load_dword v16, v23, s[40:43], 0 offen sc1
    s_waitcnt vmcnt(0)
    s_branch Lp_13
Lp_14:
    v_mov_b32 v9, 1
    ds_write_b32 v8, v9
    s_branch L_tseen
L_tw:
    s_mov_b32 s91, 0
L_tw1:
    ds_read_b32 v9, v8
    s_add_u32 s91, s91, 1
    s_cmp_gt_u32 s91, 0x1000000
    s_cbranch_scc1 L_end
    s_waitcnt lgkmcnt(0)
    v_readfirstlane_b32 s3, v9
    s_cmp_eq_u32 s3, 0
    s_cbranch_scc1 L_tw1
L_tseen:
    s_add_u32 m0, s60, 0
    s_add_u32 s59, s58, s63
    s_add_u32 s63, s63, 2048
    s_and_b32 s63, s63, 0x3fff
    buffer_load_dwordx4 v2, s[40:43], s59 offen offset:0 sc1 lds
    buffer_load_dwordx4 v6, s[40:43], s59 offen offset:1024 sc1 lds
    buffer_load_dwordx4 v7, s[40:43], s59 offen offset:2048 sc1 lds
    s_add_u32 m0, s60, 12288
    s_add_u32 s59, s58, s63
    s_add_u32 s63, s63, 2048
    s_and_b32 s63, s63, 0x3fff
    buffer_load_dwordx4 v2, s[40:43], s59 offen offset:0 sc1 lds
    buffer_load_dwordx4 v6, s[40:43], s59 offen offset:1024 sc1 lds
    buffer_load_dwordx4 v7, s[40:43], s59 offen offset:2048 sc1 lds
    s_add_u32 m0, s60, 24576
    s_add_u32 s59, s58, s63
    s_add_u32 s63, s63, 2048
    s_and_b32 s63, s63, 0x3fff
    buffer_load_dwordx4 v2, s[40:43], s59 offen offset:0 sc1 lds
    buffer_load_dwordx4 v6, s[40:43], s59 offen offset:1024 sc1 lds
    buffer_load_dwordx4 v7, s[40:43], s59 offen offset:2048 sc1 lds
    s_add_u32 m0, s60, 36864
    s_add_u32 s59, s58, s63
    s_add_u32 s63, s63, 2048
    s_and_b32 s63, s63, 0x3fff
    buffer_load_dwordx4 v2, s[40:43], s59 offen offset:0 sc1 lds
    buffer_load_dwordx4 v6, s[40:43], s59 offen offset:1024 sc1 lds
    buffer_load_dwordx4 v7, s[40:43], s59 offen offset:2048 sc1 lds
    s_waitcnt vmcnt(9)
    s_barrier
    s_add_u32 m0, s60, 49152
    s_add_u32 s59, s58, s63
    s_add_u32 s63, s63, 2048
    s_and_b32 s63, s63, 0x3fff
    buffer_load_dwordx4 v2, s[40:43], s59 offen offset:0 sc1 lds
    buffer_load_dwordx4 v6, s[40:43], s59 offen offset:1024 sc1 lds
    buffer_load_dwordx4 v7, s[40:43], s59 offen offset:2048 sc1 lds
    s_waitcnt vmcnt(9)
    s_barrier
    s_add_u32 m0, s60, 61440
    s_add_u32 s59, s58, s63
    s_add_u32 s63, s63, 2048
    s_and_b32 s63, s63, 0x3fff
    buffer_load_dwordx4 v2, s[40:43], s59 offen offset:0 sc1 lds
    buffer_load_dwordx4 v6, s[40:43], s59 offen offset:1024 sc1 lds
    buffer_load_dwordx4 v7, s[40:43], s59 offen offset:2048 sc1 lds
    s_add_u32 m0, s60, 73728
    s_add_u32 s59, s58, s63
    s_add_u32 s63, s63, 2048
    s_and_b32 s63, s63, 0x3fff
    buffer_load_dwordx4 v2, s[40:43], s59 offen offset:0 sc1 lds
    buffer_load_dwordx4 v6, s[40:43], s59 offen offset:1024 sc1 lds
    buffer_load_dwordx4 v7, s[40:43], s59 offen offset:2048 sc1 lds
    s_waitcnt vmcnt(9)
    s_barrier
    s_add_u32 m0, s60, 86016
    s_add_u32 s59, s58, s63
    s_add_u32 s63, s63, 2048
    s_and_b32 s63, s63, 0x3fff
    buffer_load_dwordx4 v2, s[40:43], s59 offen offset:0 sc1 lds
    buffer_load_dwordx4 v6, s[40:43], s59 offen offset:1024 sc1 lds
    buffer_load_dwordx4 v7, s[40:43], s59 offen offset:2048 sc1 lds
    s_add_u32 m0, s60, 98304
    s_add_u32 s59, s58, 16384
    buffer_load_dwordx4 v2, s[40:43], s59 offen offset:0 sc1 lds
    buffer_load_dwordx4 v6, s[40:43], s59 offen offset:1024 sc1 lds
    buffer_load_dwordx4 v7, s[40:43], s59 offen offset:2048 sc1 lds
    s_waitcnt vmcnt(9)
    s_barrier
    s_add_u32 m0, s60, 110592
    s_add_u32 s59, s58, 18432
    buffer_load_dwordx4 v2, s[40:43], s59 offen offset:0 sc1 lds
    buffer_load_dwordx4 v6, s[40:43], s59 offen offset:1024 sc1 lds
    buffer_load_dwordx4 v7, s[40:43], s59 offen offset:2048 sc1 lds
    s_waitcnt vmcnt(0)
    s_barrier
L_fin:
L_end:
    s_endpgm
.section .rodata,"a"
.p2align 6
.amdhsa_kernel standalone__weight_only_int_quip__prompt_kernel
  .amdhsa_next_free_vgpr 256
  .amdhsa_next_free_sgpr 100
  .amdhsa_accum_offset 112
  .amdhsa_group_segment_fixed_size 0
  .amdhsa_kernarg_size 72
  .amdhsa_user_sgpr_count 2
  .amdhsa_user_sgpr_kernarg_segment_ptr 1
  .amdhsa_system_sgpr_workgroup_id_x 1
.end_amdhsa_kernel
```
